```python
import torch

def _softmax(x, axis=-1):
    return torch.softmax(x, dim=axis)
def _gelu(x):
    return torch.nn.functional.gelu(x, approximate="tanh")
def _silu(x):
    return torch.nn.functional.silu(x)
def _sigmoid(x):
    return torch.sigmoid(x)
def _layernorm(x, axis=-1, eps=1e-5):
    m = x.mean(dim=axis, keepdim=True)
    v = x.var(dim=axis, keepdim=True, unbiased=False)
    return (x - m) / torch.sqrt(v + eps)
def _scatter_add(tgt, idx, src, axis=0):
    return tgt.clone().index_add_(axis, idx, src)
def _segment_sum(src, seg, n):
    out = torch.zeros((n,) + src.shape[1:], dtype=src.dtype)
    return out.index_add_(0, seg, src)
def _pad(x, pw):
    flat = tuple(v for pair in reversed(pw) for v in pair)
    return torch.nn.functional.pad(x, flat)

kernel_name = 'sequential_preLN__grouped_kv_mqa__moe_arch_mod__prompt'

def setup_inputs():

    _w = (lambda a: (lambda t: t.to(torch.bfloat16) if t.is_floating_point() else t)(torch.as_tensor(a)))
    def _A_setup():
        B, S, D, H = 1, 2048, 512, 32
        Dh = D // H
        return {
            "x": _w((lambda *s: torch.randn(*s, dtype=torch.bfloat16) * 0.05)(B, S, D)),
            "wq": _w((lambda *s: torch.randn(*s, dtype=torch.bfloat16) * 0.2)(D, H * Dh)),
            "wk": _w((lambda *s: torch.randn(*s, dtype=torch.bfloat16) * 0.2)(D, Dh)),
            "wv": _w((lambda *s: torch.randn(*s, dtype=torch.bfloat16) * 0.2)(D, Dh)),
            "wo": _w((lambda *s: torch.randn(*s, dtype=torch.bfloat16) * 0.2)(H * Dh, D)),
        }
    _A_in = _A_setup()

    def _B_setup():
        B, S, D, F, C = 1, 2048, 512, 1376, 2
        return {
            "x": _w((lambda *s: torch.randn(*s, dtype=torch.bfloat16) * 0.05)(B, S, D)),
            "w_r": _w((lambda *s: torch.randn(*s, dtype=torch.bfloat16) * 0.2)(D)),
            "w_gate": _w((lambda *s: torch.randn(*s, dtype=torch.bfloat16) * 0.2)(D, F)),
            "w_up": _w((lambda *s: torch.randn(*s, dtype=torch.bfloat16) * 0.2)(D, F)),
            "w_down": _w((lambda *s: torch.randn(*s, dtype=torch.bfloat16) * 0.2)(F, D)),
        }
    _B_in = _B_setup()

    return {
        "A_x": _A_in["x"],
        "A_wq": _A_in["wq"],
        "A_wk": _A_in["wk"],
        "A_wv": _A_in["wv"],
        "A_wo": _A_in["wo"],
        "B_x": _B_in["x"],
        "B_w_r": _B_in["w_r"],
        "B_w_gate": _B_in["w_gate"],
        "B_w_up": _B_in["w_up"],
        "B_w_down": _B_in["w_down"],
    }

def reference(A_x, A_wq, A_wk, A_wv, A_wo, B_x, B_w_r, B_w_gate, B_w_up, B_w_down):
    def _A_ref(x, wq, wk, wv, wo):
        B, S, D = x.shape
        H = 32
        Dh = D // H
        q = (lambda x, *d: x.permute(*d))((x @ wq).reshape(B, S, H, Dh), 0, 2, 1, 3)
        k = x @ wk
        v = x @ wv
        scores = torch.einsum("bhqd,bkd->bhqk", q, k) * (Dh ** -0.5)
        p = _softmax(scores, axis=-1)
        o = torch.einsum("bhqk,bkd->bhqd", p, v)
        return (lambda x, *d: x.permute(*d))(o, 0, 2, 1, 3).reshape(B, S, H * Dh) @ wo

    def _B_ref(x, w_r, w_gate, w_up, w_down):
        B, S, D = x.shape
        C = 2
        r = x @ w_r
        idx = torch.argsort(-r, axis=-1)[:, :C]
        idx_e = (lambda x, n, axis: torch.repeat_interleave(x, n, dim=axis))(idx.reshape(B, C, 1), D, axis=2)
        x_sel = (lambda x, i, axis: torch.take_along_dim(x, i, dim=axis))(x, idx_e, axis=1)
        g = _silu(x_sel @ w_gate)
        u = x_sel @ w_up
        y = (g * u) @ w_down
        r_sel = _sigmoid((lambda x, i, axis: torch.take_along_dim(x, i, dim=axis))(r, idx, axis=1))
        y = y * r_sel.reshape(B, C, 1)
        b_off = (torch.arange(B) * S).reshape(B, 1)
        flat_idx = (idx + b_off).reshape(B * C)
        zero = (x * 0.0).reshape(B * S, D)
        upd = _scatter_add(zero, flat_idx, y.reshape(B * C, D), axis=0)
        return x + upd.reshape(B, S, D)

    x = A_x
    h = x + _A_ref(_layernorm(x, axis=-1), A_wq, A_wk, A_wv, A_wo)
    h2 = h + _B_ref(_layernorm(h, axis=-1), B_w_r, B_w_gate, B_w_up, B_w_down)
    return h2
```

```asm
; @launch grid=(256,1,1) block=(512,1,1) lds=161792
.amdgcn_target "amdgcn-amd-amdhsa--gfx950"
.text
.globl sequential_preLN__grouped_kv_mqa__moe_arch_mod__prompt_kernel
.p2align 8
.type sequential_preLN__grouped_kv_mqa__moe_arch_mod__prompt_kernel,@function
sequential_preLN__grouped_kv_mqa__moe_arch_mod__prompt_kernel:
    s_cmp_ge_u32 s2, 256
    s_cbranch_scc1 B_done
    s_load_dwordx4 s[4:7], s[0:1], 0
    s_load_dwordx4 s[8:11], s[0:1], 16
    v_readfirstlane_b32 s36, v0
    v_and_b32 v1, 63, v0
    s_and_b32 s37, s2, 7
    s_lshr_b32 s39, s2, 5
    s_lshl3_add_u32 s37, s39, s37
    v_lshlrev_b32 v2, 4, v1
    s_lshr_b32 s36, s36, 6
    s_mov_b32 s19, 0x20000
    s_getpc_b64 s[52:53]
A_pc:
    v_lshlrev_b32 v7, 7, v1
    s_and_b32 s53, s53, 0xffff
    s_mov_b32 s54, CODE_END-A_pc
    s_mov_b32 s55, 0x20000
    s_and_b32 s62, s2, 56
    s_add_u32 s62, s62, s36
    s_lshl_b32 s62, s62, 9
    s_mov_b64 exec, 15
    buffer_load_dword v255, v7, s[52:55], s62 offen
    s_mov_b64 exec, -1
    s_lshl3_add_u32 s42, s37, s36
    s_lshl_b32 s42, s42, 12
    s_mov_b32 s18, 0x200000
    s_waitcnt lgkmcnt(0)
    s_mov_b32 s16, s4
    s_and_b32 s17, s5, 0xffff
    buffer_load_dwordx4 v[8:11], v2, s[16:19], s42 offen offset:0
    buffer_load_dwordx4 v[12:15], v2, s[16:19], s42 offen offset:1024
    buffer_load_dwordx4 v[16:19], v2, s[16:19], s42 offen offset:2048
    buffer_load_dwordx4 v[20:23], v2, s[16:19], s42 offen offset:3072
    s_load_dwordx2 s[12:13], s[0:1], 32
    s_load_dwordx2 s[14:15], s[0:1], 96
    s_bfe_u32 s38, s2, 0x20003
    s_lshr_b32 s40, s37, 2
    v_and_b32 v5, 15, v1
    v_lshrrev_b32 v6, 4, v1
    s_cmp_lt_u32 s38, 2
    s_cselect_b32 s8, s8, s10
    s_cselect_b32 s9, s9, s11
    s_mov_b32 s24, s8
    s_and_b32 s25, s9, 0xffff
    s_mov_b32 s26, 0x4000
    s_mov_b32 s27, 0x20000
    s_mov_b32 s20, s6
    s_and_b32 s21, s7, 0xffff
    s_mov_b32 s22, 0x80000
    s_mov_b32 s23, 0x20000
    s_lshl_b32 s47, s36, 11
    s_lshl_b32 s48, s40, 10
    s_xor_b32 s48, s48, s47
    s_add_u32 s47, s47, 43008
    s_barrier
    s_add_u32 m0, s47, 0
    s_xor_b32 s45, s48, 0
    buffer_load_dwordx4 v2, s[24:27], s45 offen lds
    s_add_u32 m0, s47, 1024
    s_xor_b32 s45, s48, 1024
    buffer_load_dwordx4 v2, s[24:27], s45 offen lds
    s_and_b32 s45, s2, 0xf8
    s_add_u32 s45, s45, s36
    s_lshl_b32 s45, s45, 11
    s_mov_b64 exec, 0xffff
    buffer_load_dword v254, v7, s[20:23], s45 offen
    s_mov_b64 exec, -1
    s_and_b32 s60, s36, 3
    s_lshl_b32 s44, s38, 8
    s_lshl_b32 s45, s60, 6
    s_add_u32 s44, s44, s45
    s_lshl_b32 s45, s40, 15
    s_add_u32 s44, s44, s45
    s_mul_i32 s46, s60, 25600
    s_add_u32 s46, s46, 59392
    s_waitcnt lgkmcnt(0)
    s_add_u32 s50, s14, 0x5e0000
    s_addc_u32 s51, s15, 0
    s_load_dword s3, s[50:51], 0
    s_mov_b32 s28, s12
    s_and_b32 s29, s13, 0xffff
    s_mov_b32 s30, 0x80000
    s_mov_b32 s31, 0x20000
    s_mov_b32 s32, s14
    s_and_b32 s33, s15, 0xffff
    s_mov_b32 s34, 0x800000
    s_mov_b32 s35, 0x20000
    s_mul_i32 s49, s36, 4160
    s_lshl_b32 s50, s40, 6
    v_xor_b32 v3, s50, v2
    v_add_u32 v3, s49, v3
    s_mov_b32 s75, 0x3f803f80
    s_bfe_u32 s62, s2, 0x40001
    s_lshl_b32 s62, s62, 15
    s_lshr_b32 s63, s2, 5
    s_lshl_b32 s63, s63, 7
    s_add_u32 s62, s62, s63
    s_and_b32 s63, s2, 1
    s_lshl_b32 s63, s63, 6
    s_add_u32 s62, s62, s63
    s_lshl_b32 s63, s36, 12
    s_add_u32 s63, s63, s62
    v_lshlrev_b32 v7, 10, v1
    s_mov_b64 exec, 15
    buffer_load_dword v144, v7, s[28:31], s63 offen
    s_mov_b64 exec, -1
    s_cmp_lg_u32 s36, 4
    s_cbranch_scc1 A_nsn
    s_lshl_b32 s50, s37, 10
    s_and_b32 s51, s38, 1
    s_lshl_b32 s51, s51, 8
    s_add_u32 s50, s50, s51
    s_lshr_b32 s51, s38, 1
    s_mul_i32 s51, s51, 0x10000
    s_add_u32 s50, s50, s51
    s_add_u32 s50, s50, 0x680000
    v_lshlrev_b32 v7, 9, v6
    v_lshl_add_u32 v7, v5, 4, v7
    v_mov_b32 v148, -1
    v_mov_b32 v149, -1
    v_mov_b32 v150, -1
    v_mov_b32 v151, -1
    s_mov_b64 exec, 0xffffffff
    buffer_store_dwordx4 v[148:151], v7, s[32:35], s50 offen sc1
    s_mov_b64 exec, -1
    s_waitcnt vmcnt(5)
    s_branch A_ln
A_nsn:
    s_waitcnt vmcnt(4)
A_ln:
    v_dot2_f32_bf16 v104, v8, s75, 0
    v_dot2_f32_bf16 v108, v8, v8, 0
    v_dot2_f32_bf16 v105, v12, s75, 0
    v_dot2_f32_bf16 v109, v12, v12, 0
    v_dot2_f32_bf16 v106, v16, s75, 0
    v_dot2_f32_bf16 v110, v16, v16, 0
    v_dot2_f32_bf16 v107, v20, s75, 0
    v_dot2_f32_bf16 v111, v20, v20, 0
    v_dot2_f32_bf16 v104, v9, s75, v104
    v_dot2_f32_bf16 v108, v9, v9, v108
    v_dot2_f32_bf16 v105, v13, s75, v105
    v_dot2_f32_bf16 v109, v13, v13, v109
    v_dot2_f32_bf16 v106, v17, s75, v106
    v_dot2_f32_bf16 v110, v17, v17, v110
    v_dot2_f32_bf16 v107, v21, s75, v107
    v_dot2_f32_bf16 v111, v21, v21, v111
    v_dot2_f32_bf16 v104, v10, s75, v104
    v_dot2_f32_bf16 v108, v10, v10, v108
    v_dot2_f32_bf16 v105, v14, s75, v105
    v_dot2_f32_bf16 v109, v14, v14, v109
    v_dot2_f32_bf16 v106, v18, s75, v106
    v_dot2_f32_bf16 v110, v18, v18, v110
    v_dot2_f32_bf16 v107, v22, s75, v107
    v_dot2_f32_bf16 v111, v22, v22, v111
    v_dot2_f32_bf16 v104, v11, s75, v104
    v_dot2_f32_bf16 v108, v11, v11, v108
    v_dot2_f32_bf16 v105, v15, s75, v105
    v_dot2_f32_bf16 v109, v15, v15, v109
    v_dot2_f32_bf16 v106, v19, s75, v106
    v_dot2_f32_bf16 v110, v19, v19, v110
    v_dot2_f32_bf16 v107, v23, s75, v107
    v_dot2_f32_bf16 v111, v23, v23, v111
    v_permlane32_swap_b32 v104, v105
    s_nop 0
    v_permlane32_swap_b32 v106, v107
    v_permlane32_swap_b32 v108, v109
    v_permlane32_swap_b32 v110, v111
    v_add_f32 v104, v104, v105
    v_add_f32 v106, v106, v107
    v_add_f32 v108, v108, v109
    v_add_f32 v110, v110, v111
    v_lshlrev_b32 v40, 16, v8
    v_and_b32 v41, 0xffff0000, v8
    v_permlane16_swap_b32 v104, v106
    v_lshlrev_b32 v42, 16, v9
    v_and_b32 v43, 0xffff0000, v9
    v_permlane16_swap_b32 v108, v110
    v_lshlrev_b32 v44, 16, v10
    v_and_b32 v45, 0xffff0000, v10
    v_add_f32 v104, v104, v106
    v_lshlrev_b32 v46, 16, v11
    v_and_b32 v47, 0xffff0000, v11
    v_add_f32 v108, v108, v110
    v_lshlrev_b32 v48, 16, v12
    v_and_b32 v49, 0xffff0000, v12
    v_add_f32_dpp v104, v104, v104 row_ror:8 row_mask:0xf bank_mask:0x3
    v_lshlrev_b32 v50, 16, v13
    v_and_b32 v51, 0xffff0000, v13
    v_add_f32_dpp v104, v108, v108 row_ror:8 row_mask:0xf bank_mask:0xc
    v_lshlrev_b32 v52, 16, v14
    v_and_b32 v53, 0xffff0000, v14
    v_add_f32_dpp v104, v104, v104 quad_perm:[1,0,3,2] row_mask:0xf bank_mask:0xf
    v_lshlrev_b32 v54, 16, v15
    v_and_b32 v55, 0xffff0000, v15
    v_add_f32_dpp v104, v104, v104 quad_perm:[2,3,0,1] row_mask:0xf bank_mask:0xf
    v_lshlrev_b32 v56, 16, v16
    v_and_b32 v57, 0xffff0000, v16
    v_add_f32_dpp v104, v104, v104 row_half_mirror row_mask:0xf bank_mask:0xf
    v_lshlrev_b32 v58, 16, v17
    v_and_b32 v59, 0xffff0000, v17
    v_mul_f32 v104, 0x3b000000, v104
    v_lshlrev_b32 v60, 16, v18
    v_and_b32 v61, 0xffff0000, v18
    v_mov_b32_dpp v105, v104 row_ror:8 row_mask:0xf bank_mask:0xf
    v_lshlrev_b32 v62, 16, v19
    v_and_b32 v63, 0xffff0000, v19
    v_fma_f32 v105, -v104, v104, v105
    v_lshlrev_b32 v64, 16, v20
    v_and_b32 v65, 0xffff0000, v20
    v_max_f32 v105, 0, v105
    v_lshlrev_b32 v66, 16, v21
    v_and_b32 v67, 0xffff0000, v21
    v_cvt_pk_bf16_f32 v105, v104, v105
    v_lshlrev_b32 v68, 16, v22
    v_and_b32 v69, 0xffff0000, v22
    v_lshlrev_b32 v104, 16, v105
    v_lshlrev_b32 v70, 16, v23
    v_and_b32 v71, 0xffff0000, v23
    v_readlane_b32 s64, v104, 0
    v_readlane_b32 s66, v104, 32
    v_readlane_b32 s68, v104, 16
    v_readlane_b32 s70, v104, 48
    v_and_b32 v105, 0xffff0000, v105
    v_pk_add_f32 v[40:41], v[40:41], s[64:65] op_sel_hi:[1,0] neg_lo:[0,1] neg_hi:[0,1]
    v_pk_add_f32 v[42:43], v[42:43], s[64:65] op_sel_hi:[1,0] neg_lo:[0,1] neg_hi:[0,1]
    v_add_f32 v105, 0x3727c5ac, v105
    v_pk_add_f32 v[44:45], v[44:45], s[64:65] op_sel_hi:[1,0] neg_lo:[0,1] neg_hi:[0,1]
    v_pk_add_f32 v[46:47], v[46:47], s[64:65] op_sel_hi:[1,0] neg_lo:[0,1] neg_hi:[0,1]
    v_cvt_pk_bf16_f32 v105, v105, v105
    v_pk_add_f32 v[48:49], v[48:49], s[66:67] op_sel_hi:[1,0] neg_lo:[0,1] neg_hi:[0,1]
    v_pk_add_f32 v[50:51], v[50:51], s[66:67] op_sel_hi:[1,0] neg_lo:[0,1] neg_hi:[0,1]
    v_and_b32 v105, 0xffff0000, v105
    v_pk_add_f32 v[52:53], v[52:53], s[66:67] op_sel_hi:[1,0] neg_lo:[0,1] neg_hi:[0,1]
    v_pk_add_f32 v[54:55], v[54:55], s[66:67] op_sel_hi:[1,0] neg_lo:[0,1] neg_hi:[0,1]
    v_sqrt_f32 v105, v105
    v_pk_add_f32 v[56:57], v[56:57], s[68:69] op_sel_hi:[1,0] neg_lo:[0,1] neg_hi:[0,1]
    v_pk_add_f32 v[58:59], v[58:59], s[68:69] op_sel_hi:[1,0] neg_lo:[0,1] neg_hi:[0,1]
    v_cvt_pk_bf16_f32 v105, v105, v105
    v_pk_add_f32 v[60:61], v[60:61], s[68:69] op_sel_hi:[1,0] neg_lo:[0,1] neg_hi:[0,1]
    v_pk_add_f32 v[62:63], v[62:63], s[68:69] op_sel_hi:[1,0] neg_lo:[0,1] neg_hi:[0,1]
    v_and_b32 v105, 0xffff0000, v105
    v_pk_add_f32 v[64:65], v[64:65], s[70:71] op_sel_hi:[1,0] neg_lo:[0,1] neg_hi:[0,1]
    v_pk_add_f32 v[66:67], v[66:67], s[70:71] op_sel_hi:[1,0] neg_lo:[0,1] neg_hi:[0,1]
    v_rcp_f32 v105, v105
    v_pk_add_f32 v[68:69], v[68:69], s[70:71] op_sel_hi:[1,0] neg_lo:[0,1] neg_hi:[0,1]
    v_pk_add_f32 v[70:71], v[70:71], s[70:71] op_sel_hi:[1,0] neg_lo:[0,1] neg_hi:[0,1]
    v_cvt_pk_bf16_f32 v72, v40, v41
    v_cvt_pk_bf16_f32 v73, v42, v43
    v_cvt_pk_bf16_f32 v74, v44, v45
    v_cvt_pk_bf16_f32 v75, v46, v47
    v_cvt_pk_bf16_f32 v76, v48, v49
    v_cvt_pk_bf16_f32 v77, v50, v51
    v_cvt_pk_bf16_f32 v78, v52, v53
    v_cvt_pk_bf16_f32 v79, v54, v55
    v_cvt_pk_bf16_f32 v80, v56, v57
    v_cvt_pk_bf16_f32 v81, v58, v59
    v_cvt_pk_bf16_f32 v82, v60, v61
    v_cvt_pk_bf16_f32 v83, v62, v63
    v_cvt_pk_bf16_f32 v84, v64, v65
    v_cvt_pk_bf16_f32 v85, v66, v67
    v_cvt_pk_bf16_f32 v86, v68, v69
    v_cvt_pk_bf16_f32 v87, v70, v71
    v_readlane_b32 s64, v105, 0
    v_readlane_b32 s66, v105, 32
    v_readlane_b32 s68, v105, 16
    v_readlane_b32 s70, v105, 48
    v_lshlrev_b32 v40, 16, v72
    v_and_b32 v41, 0xffff0000, v72
    v_lshlrev_b32 v42, 16, v73
    v_and_b32 v43, 0xffff0000, v73
    v_lshlrev_b32 v44, 16, v74
    v_and_b32 v45, 0xffff0000, v74
    v_lshlrev_b32 v46, 16, v75
    v_and_b32 v47, 0xffff0000, v75
    v_lshlrev_b32 v48, 16, v76
    v_and_b32 v49, 0xffff0000, v76
    v_lshlrev_b32 v50, 16, v77
    v_and_b32 v51, 0xffff0000, v77
    v_lshlrev_b32 v52, 16, v78
    v_and_b32 v53, 0xffff0000, v78
    v_lshlrev_b32 v54, 16, v79
    v_and_b32 v55, 0xffff0000, v79
    v_lshlrev_b32 v56, 16, v80
    v_and_b32 v57, 0xffff0000, v80
    v_lshlrev_b32 v58, 16, v81
    v_and_b32 v59, 0xffff0000, v81
    v_lshlrev_b32 v60, 16, v82
    v_and_b32 v61, 0xffff0000, v82
    v_lshlrev_b32 v62, 16, v83
    v_and_b32 v63, 0xffff0000, v83
    v_lshlrev_b32 v64, 16, v84
    v_and_b32 v65, 0xffff0000, v84
    v_lshlrev_b32 v66, 16, v85
    v_and_b32 v67, 0xffff0000, v85
    v_lshlrev_b32 v68, 16, v86
    v_and_b32 v69, 0xffff0000, v86
    v_lshlrev_b32 v70, 16, v87
    v_and_b32 v71, 0xffff0000, v87
    v_pk_mul_f32 v[40:41], v[40:41], s[64:65] op_sel_hi:[1,0]
    v_pk_mul_f32 v[42:43], v[42:43], s[64:65] op_sel_hi:[1,0]
    v_pk_mul_f32 v[44:45], v[44:45], s[64:65] op_sel_hi:[1,0]
    v_pk_mul_f32 v[46:47], v[46:47], s[64:65] op_sel_hi:[1,0]
    v_cvt_pk_bf16_f32 v72, v40, v41
    v_cvt_pk_bf16_f32 v73, v42, v43
    v_cvt_pk_bf16_f32 v74, v44, v45
    v_cvt_pk_bf16_f32 v75, v46, v47
    ds_write_b128 v3, v[72:75] offset:0
    v_pk_mul_f32 v[48:49], v[48:49], s[66:67] op_sel_hi:[1,0]
    v_pk_mul_f32 v[50:51], v[50:51], s[66:67] op_sel_hi:[1,0]
    v_pk_mul_f32 v[52:53], v[52:53], s[66:67] op_sel_hi:[1,0]
    v_pk_mul_f32 v[54:55], v[54:55], s[66:67] op_sel_hi:[1,0]
    v_cvt_pk_bf16_f32 v76, v48, v49
    v_cvt_pk_bf16_f32 v77, v50, v51
    v_cvt_pk_bf16_f32 v78, v52, v53
    v_cvt_pk_bf16_f32 v79, v54, v55
    ds_write_b128 v3, v[76:79] offset:1040
    v_pk_mul_f32 v[56:57], v[56:57], s[68:69] op_sel_hi:[1,0]
    v_pk_mul_f32 v[58:59], v[58:59], s[68:69] op_sel_hi:[1,0]
    v_pk_mul_f32 v[60:61], v[60:61], s[68:69] op_sel_hi:[1,0]
    v_pk_mul_f32 v[62:63], v[62:63], s[68:69] op_sel_hi:[1,0]
    v_cvt_pk_bf16_f32 v80, v56, v57
    v_cvt_pk_bf16_f32 v81, v58, v59
    v_cvt_pk_bf16_f32 v82, v60, v61
    v_cvt_pk_bf16_f32 v83, v62, v63
    ds_write_b128 v3, v[80:83] offset:2080
    v_pk_mul_f32 v[64:65], v[64:65], s[70:71] op_sel_hi:[1,0]
    v_pk_mul_f32 v[66:67], v[66:67], s[70:71] op_sel_hi:[1,0]
    v_pk_mul_f32 v[68:69], v[68:69], s[70:71] op_sel_hi:[1,0]
    v_pk_mul_f32 v[70:71], v[70:71], s[70:71] op_sel_hi:[1,0]
    v_cvt_pk_bf16_f32 v84, v64, v65
    v_cvt_pk_bf16_f32 v85, v66, v67
    v_cvt_pk_bf16_f32 v86, v68, v69
    v_cvt_pk_bf16_f32 v87, v70, v71
    ds_write_b128 v3, v[84:87] offset:3120
    s_waitcnt lgkmcnt(0)
    s_mul_i32 s3, s3, 0x9e3779b1
    s_add_u32 s3, s3, 0x7f4a7c15
    s_or_b32 s3, s3, 1
    s_cmp_lt_u32 s36, 4
    s_cbranch_scc1 A_gemm
    s_cmp_eq_u32 s36, 4
    s_cbranch_scc1 A_w0
    s_waitcnt vmcnt(2) lgkmcnt(0)
    s_barrier
    s_branch J_in
A_w0:
    v_mov_b32 v152, s3
    s_setprio 3
    v_mul_u32_u24 v3, 1040, v5
    v_lshl_add_u32 v3, v6, 4, v3
    s_and_b32 s48, s38, 1
    s_mul_i32 s49, s48, 16640
    v_add_u32 v3, s49, v3
    v_lshlrev_b32 v4, 8, v6
    v_lshl_add_u32 v4, v5, 3, v4
    s_waitcnt vmcnt(3) lgkmcnt(0)
    s_barrier
    ds_read_b64_tr_b16 v[8:9], v4 offset:43008
    ds_read_b64_tr_b16 v[10:11], v4 offset:43136
    ds_read_b128 v[72:75], v3 offset:0
    ds_read_b64_tr_b16 v[12:13], v4 offset:44032
    ds_read_b64_tr_b16 v[14:15], v4 offset:44160
    ds_read_b128 v[76:79], v3 offset:64
    ds_read_b64_tr_b16 v[16:17], v4 offset:45056
    ds_read_b64_tr_b16 v[18:19], v4 offset:45184
    ds_read_b128 v[80:83], v3 offset:128
    ds_read_b64_tr_b16 v[20:21], v4 offset:46080
    ds_read_b64_tr_b16 v[22:23], v4 offset:46208
    ds_read_b128 v[84:87], v3 offset:192
    ds_read_b64_tr_b16 v[24:25], v4 offset:47104
    ds_read_b64_tr_b16 v[26:27], v4 offset:47232
    ds_read_b128 v[88:91], v3 offset:256
    ds_read_b64_tr_b16 v[28:29], v4 offset:48128
    ds_read_b64_tr_b16 v[30:31], v4 offset:48256
    ds_read_b128 v[92:95], v3 offset:320
    ds_read_b64_tr_b16 v[32:33], v4 offset:49152
    ds_read_b64_tr_b16 v[34:35], v4 offset:49280
    ds_read_b128 v[96:99], v3 offset:384
    ds_read_b64_tr_b16 v[36:37], v4 offset:50176
    ds_read_b64_tr_b16 v[38:39], v4 offset:50304
    ds_read_b128 v[100:103], v3 offset:448
    ds_read_b64_tr_b16 v[40:41], v4 offset:51200
    ds_read_b64_tr_b16 v[42:43], v4 offset:51328
    ds_read_b128 v[104:107], v3 offset:512
    ds_read_b64_tr_b16 v[44:45], v4 offset:52224
    ds_read_b64_tr_b16 v[46:47], v4 offset:52352
    ds_read_b128 v[108:111], v3 offset:576
    ds_read_b64_tr_b16 v[48:49], v4 offset:53248
    ds_read_b64_tr_b16 v[50:51], v4 offset:53376
    ds_read_b128 v[112:115], v3 offset:640
    ds_read_b64_tr_b16 v[52:53], v4 offset:54272
    ds_read_b64_tr_b16 v[54:55], v4 offset:54400
    ds_read_b128 v[116:119], v3 offset:704
    ds_read_b64_tr_b16 v[56:57], v4 offset:55296
    ds_read_b64_tr_b16 v[58:59], v4 offset:55424
    ds_read_b128 v[120:123], v3 offset:768
    ds_read_b64_tr_b16 v[60:61], v4 offset:56320
    ds_read_b64_tr_b16 v[62:63], v4 offset:56448
    ds_read_b128 v[124:127], v3 offset:832
    ds_read_b64_tr_b16 v[64:65], v4 offset:57344
    ds_read_b64_tr_b16 v[66:67], v4 offset:57472
    ds_read_b128 v[128:131], v3 offset:896
    ds_read_b64_tr_b16 v[68:69], v4 offset:58368
    ds_read_b64_tr_b16 v[70:71], v4 offset:58496
    ds_read_b128 v[132:135], v3 offset:960
    s_waitcnt lgkmcnt(0)
    s_cmp_lt_u32 s38, 2
    s_cbranch_scc0 A_v
    v_mfma_f32_16x16x32_bf16 v[136:139], v[8:11], v[72:75], 0
    v_mfma_f32_16x16x32_bf16 v[140:143], v[12:15], v[76:79], 0
    v_mfma_f32_16x16x32_bf16 v[136:139], v[16:19], v[80:83], v[136:139]
    v_mfma_f32_16x16x32_bf16 v[140:143], v[20:23], v[84:87], v[140:143]
    v_mfma_f32_16x16x32_bf16 v[136:139], v[24:27], v[88:91], v[136:139]
    v_mfma_f32_16x16x32_bf16 v[140:143], v[28:31], v[92:95], v[140:143]
    v_mfma_f32_16x16x32_bf16 v[136:139], v[32:35], v[96:99], v[136:139]
    v_mfma_f32_16x16x32_bf16 v[140:143], v[36:39], v[100:103], v[140:143]
    v_mfma_f32_16x16x32_bf16 v[136:139], v[40:43], v[104:107], v[136:139]
    v_mfma_f32_16x16x32_bf16 v[140:143], v[44:47], v[108:111], v[140:143]
    v_mfma_f32_16x16x32_bf16 v[136:139], v[48:51], v[112:115], v[136:139]
    v_mfma_f32_16x16x32_bf16 v[140:143], v[52:55], v[116:119], v[140:143]
    v_mfma_f32_16x16x32_bf16 v[136:139], v[56:59], v[120:123], v[136:139]
    v_mfma_f32_16x16x32_bf16 v[140:143], v[60:63], v[124:127], v[140:143]
    v_mfma_f32_16x16x32_bf16 v[136:139], v[64:67], v[128:131], v[136:139]
    v_mfma_f32_16x16x32_bf16 v[140:143], v[68:71], v[132:135], v[140:143]
    v_and_b32 v7, 1, v6
    v_lshlrev_b32 v7, 9, v7
    v_lshl_add_u32 v7, v5, 4, v7
    v_lshrrev_b32 v0, 1, v6
    v_lshl_add_u32 v7, v0, 3, v7
    s_lshl_b32 s47, s37, 10
    s_lshl_b32 s48, s48, 8
    s_add_u32 s47, s47, s48
    s_add_u32 s47, s47, 0x680000
    s_mov_b32 s50, 1.0
    s_branch A_kvs
A_v:
    v_mfma_f32_16x16x32_bf16 v[136:139], v[72:75], v[8:11], 0
    v_mfma_f32_16x16x32_bf16 v[140:143], v[76:79], v[12:15], 0
    v_mfma_f32_16x16x32_bf16 v[136:139], v[80:83], v[16:19], v[136:139]
    v_mfma_f32_16x16x32_bf16 v[140:143], v[84:87], v[20:23], v[140:143]
    v_mfma_f32_16x16x32_bf16 v[136:139], v[88:91], v[24:27], v[136:139]
    v_mfma_f32_16x16x32_bf16 v[140:143], v[92:95], v[28:31], v[140:143]
    v_mfma_f32_16x16x32_bf16 v[136:139], v[96:99], v[32:35], v[136:139]
    v_mfma_f32_16x16x32_bf16 v[140:143], v[100:103], v[36:39], v[140:143]
    v_mfma_f32_16x16x32_bf16 v[136:139], v[104:107], v[40:43], v[136:139]
    v_mfma_f32_16x16x32_bf16 v[140:143], v[108:111], v[44:47], v[140:143]
    v_mfma_f32_16x16x32_bf16 v[136:139], v[112:115], v[48:51], v[136:139]
    v_mfma_f32_16x16x32_bf16 v[140:143], v[116:119], v[52:55], v[140:143]
    v_mfma_f32_16x16x32_bf16 v[136:139], v[120:123], v[56:59], v[136:139]
    v_mfma_f32_16x16x32_bf16 v[140:143], v[124:127], v[60:63], v[140:143]
    v_mfma_f32_16x16x32_bf16 v[136:139], v[128:131], v[64:67], v[136:139]
    v_mfma_f32_16x16x32_bf16 v[140:143], v[132:135], v[68:71], v[140:143]
    v_lshrrev_b32 v7, 1, v6
    v_lshlrev_b32 v7, 9, v7
    v_lshl_add_u32 v7, v5, 4, v7
    v_and_b32 v0, 1, v6
    v_lshl_add_u32 v7, v0, 3, v7
    s_lshl_b32 s47, s37, 10
    s_lshl_b32 s48, s48, 8
    s_add_u32 s47, s47, s48
    s_add_u32 s47, s47, 0x690000
    s_mov_b32 s50, 0x45800000
A_kvs:
    v_pk_add_f32 v[136:137], v[136:137], v[140:141]
    v_pk_add_f32 v[138:139], v[138:139], v[142:143]
    v_pk_mul_f32 v[136:137], v[136:137], s[50:51] op_sel_hi:[1,0]
    v_pk_mul_f32 v[138:139], v[138:139], s[50:51] op_sel_hi:[1,0]
    v_cvt_pk_bf16_f32 v140, v136, v137
    v_cvt_pk_bf16_f32 v141, v138, v139
    v_min_u32 v140, 0xfffeffff, v140
    v_min_u32 v141, 0xfffeffff, v141
    s_mov_b32 s46, 1048576
    v_lshrrev_b32 v3, 3, v1
    v_lshlrev_b32 v3, 15, v3
    v_and_b32 v0, 7, v1
    v_lshl_add_u32 v3, v0, 4, v3
    s_lshl_b32 s63, s2, 7
    s_add_u32 s63, s63, 0x580000
    s_waitcnt vmcnt(0)
    buffer_store_dwordx2 v[140:141], v7, s[32:35], s47 offen sc1
    buffer_store_dwordx4 v[152:155], v3, s[32:35], s63 offen sc1
    s_mov_b64 exec, -1
A_rst:
    s_branch J_in
A_gemm:
    v_lshrrev_b32 v7, 2, v1
    v_lshlrev_b32 v3, 10, v7
    v_and_b32 v7, 3, v1
    v_lshl_add_u32 v3, v7, 4, v3
    s_waitcnt vmcnt(2)
    s_cmp_lg_u32 s36, 3
    s_cbranch_scc1 A_nw
    v_lshlrev_b32 v7, 13, v6
    v_lshl_add_u32 v7, v5, 2, v7
    s_add_u32 s63, s62, 4096
    buffer_load_dword v200, v7, s[28:31], s62 offen offset:0
    buffer_load_dword v201, v7, s[28:31], s62 offen offset:1024
    buffer_load_dword v202, v7, s[28:31], s62 offen offset:2048
    buffer_load_dword v203, v7, s[28:31], s62 offen offset:3072
    buffer_load_dword v204, v7, s[28:31], s63 offen offset:0
    buffer_load_dword v205, v7, s[28:31], s63 offen offset:1024
    buffer_load_dword v206, v7, s[28:31], s63 offen offset:2048
    buffer_load_dword v207, v7, s[28:31], s63 offen offset:3072
A_nw:
    s_add_u32 m0, s46, 0
    s_xor_b32 s45, s44, 0
    buffer_load_dwordx4 v3, s[20:23], s45 offen lds
    s_add_u32 m0, s46, 1024
    s_xor_b32 s45, s44, 16384
    buffer_load_dwordx4 v3, s[20:23], s45 offen lds
    s_add_u32 m0, s46, 2048
    s_xor_b32 s45, s44, 32768
    buffer_load_dwordx4 v3, s[20:23], s45 offen lds
    s_add_u32 m0, s46, 3072
    s_xor_b32 s45, s44, 49152
    buffer_load_dwordx4 v3, s[20:23], s45 offen lds
    s_add_u32 m0, s46, 4096
    s_xor_b32 s45, s44, 65536
    buffer_load_dwordx4 v3, s[20:23], s45 offen lds
    s_add_u32 m0, s46, 5120
    s_xor_b32 s45, s44, 81920
    buffer_load_dwordx4 v3, s[20:23], s45 offen lds
    s_waitcnt lgkmcnt(0)
    s_barrier
    s_add_u32 m0, s46, 6144
    s_xor_b32 s45, s44, 98304
    buffer_load_dwordx4 v3, s[20:23], s45 offen lds
    s_add_u32 m0, s46, 7168
    s_xor_b32 s45, s44, 114688
    buffer_load_dwordx4 v3, s[20:23], s45 offen lds
    s_add_u32 m0, s46, 8192
    s_xor_b32 s45, s44, 131072
    buffer_load_dwordx4 v3, s[20:23], s45 offen lds
    s_add_u32 m0, s46, 9216
    s_xor_b32 s45, s44, 147456
    buffer_load_dwordx4 v3, s[20:23], s45 offen lds
    s_add_u32 m0, s46, 10240
    s_xor_b32 s45, s44, 163840
    buffer_load_dwordx4 v3, s[20:23], s45 offen lds
    s_add_u32 m0, s46, 11264
    s_xor_b32 s45, s44, 180224
    buffer_load_dwordx4 v3, s[20:23], s45 offen lds
    v_lshrrev_b32 v7, 5, v1
    v_bfe_u32 v4, v1, 2, 2
    v_lshl_add_u32 v4, v7, 3, v4
    v_lshlrev_b32 v4, 6, v4
    v_and_b32 v7, 1, v6
    v_lshl_add_u32 v4, v7, 5, v4
    v_and_b32 v7, 3, v1
    v_lshl_add_u32 v4, v7, 3, v4
    v_add_u32 v4, s46, v4
    v_and_b32 v7, 31, v1
    v_mul_u32_u24 v0, 1040, v7
    v_lshrrev_b32 v7, 5, v1
    v_lshl_add_u32 v0, v7, 4, v0
    v_bfe_u32 v6, v1, 3, 2
    v_lshlrev_b32 v6, 13, v6
    v_lshl_add_u32 v6, v7, 9, v6
    v_and_b32 v7, 7, v1
    v_lshl_add_u32 v6, v7, 4, v6
    s_lshl_b32 s49, s38, 1
    s_lshr_b32 s50, s60, 1
    s_add_u32 s49, s49, s50
    s_lshl_b32 s49, s49, 10
    s_and_b32 s50, s60, 1
    s_lshl_b32 s50, s50, 8
    s_add_u32 s49, s49, s50
    s_lshl_b32 s50, s37, 15
    s_add_u32 s49, s49, s50
    s_mov_b32 s64, 0x3eb8aa3b
    s_setprio 2
    s_waitcnt vmcnt(11)
    ds_read_b64_tr_b16 v[8:9], v4 offset:0
    ds_read_b64_tr_b16 v[10:11], v4 offset:256
    ds_read_b128 v[136:139], v0 offset:0
    s_waitcnt vmcnt(10)
    ds_read_b64_tr_b16 v[12:13], v4 offset:1024
    ds_read_b64_tr_b16 v[14:15], v4 offset:1280
    ds_read_b128 v[140:143], v0 offset:32
    s_waitcnt vmcnt(9)
    ds_read_b64_tr_b16 v[16:17], v4 offset:2048
    ds_read_b64_tr_b16 v[18:19], v4 offset:2304
    ds_read_b128 v[144:147], v0 offset:64
    s_waitcnt lgkmcnt(6)
    v_mfma_f32_32x32x16_bf16 v[168:183], v[8:11], v[136:139], 0
    s_add_u32 m0, s46, 12288
    s_xor_b32 s45, s44, 196608
    buffer_load_dwordx4 v3, s[20:23], s45 offen lds
    s_add_u32 m0, s46, 13312
    s_xor_b32 s45, s44, 212992
    buffer_load_dwordx4 v3, s[20:23], s45 offen lds
    s_waitcnt vmcnt(10)
    ds_read_b64_tr_b16 v[20:21], v4 offset:3072
    ds_read_b64_tr_b16 v[22:23], v4 offset:3328
    ds_read_b128 v[148:151], v0 offset:96
    s_waitcnt lgkmcnt(6)
    v_mfma_f32_32x32x16_bf16 v[168:183], v[12:15], v[140:143], v[168:183]
    s_add_u32 m0, s46, 14336
    s_xor_b32 s45, s44, 229376
    buffer_load_dwordx4 v3, s[20:23], s45 offen lds
    s_add_u32 m0, s46, 15360
    s_xor_b32 s45, s44, 245760
    buffer_load_dwordx4 v3, s[20:23], s45 offen lds
    s_waitcnt vmcnt(11)
    ds_read_b64_tr_b16 v[24:25], v4 offset:4096
    ds_read_b64_tr_b16 v[26:27], v4 offset:4352
    ds_read_b128 v[152:155], v0 offset:128
    s_waitcnt lgkmcnt(6)
    v_mfma_f32_32x32x16_bf16 v[168:183], v[16:19], v[144:147], v[168:183]
    s_add_u32 m0, s46, 16384
    s_xor_b32 s45, s44, 262144
    buffer_load_dwordx4 v3, s[20:23], s45 offen lds
    s_waitcnt vmcnt(11)
    ds_read_b64_tr_b16 v[28:29], v4 offset:5120
    ds_read_b64_tr_b16 v[30:31], v4 offset:5376
    ds_read_b128 v[156:159], v0 offset:160
    s_waitcnt lgkmcnt(6)
    v_mfma_f32_32x32x16_bf16 v[168:183], v[20:23], v[148:151], v[168:183]
    s_add_u32 m0, s46, 17408
    s_xor_b32 s45, s44, 278528
    buffer_load_dwordx4 v3, s[20:23], s45 offen lds
    s_add_u32 m0, s46, 18432
    s_xor_b32 s45, s44, 294912
    buffer_load_dwordx4 v3, s[20:23], s45 offen lds
    s_waitcnt vmcnt(12)
    ds_read_b64_tr_b16 v[32:33], v4 offset:6144
    ds_read_b64_tr_b16 v[34:35], v4 offset:6400
    ds_read_b128 v[160:163], v0 offset:192
    s_waitcnt lgkmcnt(6)
    v_mfma_f32_32x32x16_bf16 v[168:183], v[24:27], v[152:155], v[168:183]
    s_add_u32 m0, s46, 19456
    s_xor_b32 s45, s44, 311296
    buffer_load_dwordx4 v3, s[20:23], s45 offen lds
    s_add_u32 m0, s46, 20480
    s_xor_b32 s45, s44, 327680
    buffer_load_dwordx4 v3, s[20:23], s45 offen lds
    s_waitcnt vmcnt(13)
    ds_read_b64_tr_b16 v[36:37], v4 offset:7168
    ds_read_b64_tr_b16 v[38:39], v4 offset:7424
    ds_read_b128 v[164:167], v0 offset:224
    s_waitcnt lgkmcnt(6)
    v_mfma_f32_32x32x16_bf16 v[168:183], v[28:31], v[156:159], v[168:183]
    s_add_u32 m0, s46, 21504
    s_xor_b32 s45, s44, 344064
    buffer_load_dwordx4 v3, s[20:23], s45 offen lds
    s_waitcnt vmcnt(13)
    ds_read_b64_tr_b16 v[40:41], v4 offset:8192
    ds_read_b64_tr_b16 v[42:43], v4 offset:8448
    ds_read_b128 v[136:139], v0 offset:256
    s_waitcnt lgkmcnt(6)
    v_mfma_f32_32x32x16_bf16 v[168:183], v[32:35], v[160:163], v[168:183]
    s_add_u32 m0, s46, 22528
    s_xor_b32 s45, s44, 360448
    buffer_load_dwordx4 v3, s[20:23], s45 offen lds
    s_add_u32 m0, s46, 23552
    s_xor_b32 s45, s44, 376832
    buffer_load_dwordx4 v3, s[20:23], s45 offen lds
    s_waitcnt vmcnt(14)
    ds_read_b64_tr_b16 v[44:45], v4 offset:9216
    ds_read_b64_tr_b16 v[46:47], v4 offset:9472
    ds_read_b128 v[140:143], v0 offset:288
    s_waitcnt lgkmcnt(6)
    v_mfma_f32_32x32x16_bf16 v[168:183], v[36:39], v[164:167], v[168:183]
    s_add_u32 m0, s46, 24576
    s_xor_b32 s45, s44, 393216
    buffer_load_dwordx4 v3, s[20:23], s45 offen lds
    s_add_u32 m0, s46, 0
    s_xor_b32 s45, s44, 409600
    buffer_load_dwordx4 v3, s[20:23], s45 offen lds
    s_waitcnt vmcnt(15)
    ds_read_b64_tr_b16 v[48:49], v4 offset:10240
    ds_read_b64_tr_b16 v[50:51], v4 offset:10496
    ds_read_b128 v[144:147], v0 offset:320
    s_waitcnt lgkmcnt(6)
    v_mfma_f32_32x32x16_bf16 v[168:183], v[40:43], v[136:139], v[168:183]
    s_add_u32 m0, s46, 1024
    s_xor_b32 s45, s44, 425984
    buffer_load_dwordx4 v3, s[20:23], s45 offen lds
    s_waitcnt vmcnt(15)
    ds_read_b64_tr_b16 v[52:53], v4 offset:11264
    ds_read_b64_tr_b16 v[54:55], v4 offset:11520
    ds_read_b128 v[148:151], v0 offset:352
    s_waitcnt lgkmcnt(6)
    v_mfma_f32_32x32x16_bf16 v[168:183], v[44:47], v[140:143], v[168:183]
    s_add_u32 m0, s46, 2048
    s_xor_b32 s45, s44, 442368
    buffer_load_dwordx4 v3, s[20:23], s45 offen lds
    s_add_u32 m0, s46, 3072
    s_xor_b32 s45, s44, 458752
    buffer_load_dwordx4 v3, s[20:23], s45 offen lds
    s_waitcnt vmcnt(16)
    ds_read_b64_tr_b16 v[56:57], v4 offset:12288
    ds_read_b64_tr_b16 v[58:59], v4 offset:12544
    ds_read_b128 v[152:155], v0 offset:384
    s_waitcnt lgkmcnt(6)
    v_mfma_f32_32x32x16_bf16 v[168:183], v[48:51], v[144:147], v[168:183]
    s_add_u32 m0, s46, 4096
    s_xor_b32 s45, s44, 475136
    buffer_load_dwordx4 v3, s[20:23], s45 offen lds
    s_add_u32 m0, s46, 5120
    s_xor_b32 s45, s44, 491520
    buffer_load_dwordx4 v3, s[20:23], s45 offen lds
    s_waitcnt vmcnt(17)
    ds_read_b64_tr_b16 v[60:61], v4 offset:13312
    ds_read_b64_tr_b16 v[62:63], v4 offset:13568
    ds_read_b128 v[156:159], v0 offset:416
    s_waitcnt lgkmcnt(6)
    v_mfma_f32_32x32x16_bf16 v[168:183], v[52:55], v[148:151], v[168:183]
    s_add_u32 m0, s46, 6144
    s_xor_b32 s45, s44, 507904
    buffer_load_dwordx4 v3, s[20:23], s45 offen lds
    s_waitcnt vmcnt(17)
    ds_read_b64_tr_b16 v[64:65], v4 offset:14336
    ds_read_b64_tr_b16 v[66:67], v4 offset:14592
    ds_read_b128 v[160:163], v0 offset:448
    s_waitcnt lgkmcnt(6)
    v_mfma_f32_32x32x16_bf16 v[168:183], v[56:59], v[152:155], v[168:183]
    s_waitcnt vmcnt(16)
    ds_read_b64_tr_b16 v[68:69], v4 offset:15360
    ds_read_b64_tr_b16 v[70:71], v4 offset:15616
    ds_read_b128 v[164:167], v0 offset:480
    s_waitcnt lgkmcnt(6)
    v_mfma_f32_32x32x16_bf16 v[168:183], v[60:63], v[156:159], v[168:183]
    s_waitcnt vmcnt(15)
    ds_read_b64_tr_b16 v[72:73], v4 offset:16384
    ds_read_b64_tr_b16 v[74:75], v4 offset:16640
    ds_read_b128 v[136:139], v0 offset:512
    s_waitcnt lgkmcnt(6)
    v_mfma_f32_32x32x16_bf16 v[168:183], v[64:67], v[160:163], v[168:183]
    s_waitcnt vmcnt(14)
    ds_read_b64_tr_b16 v[76:77], v4 offset:17408
    ds_read_b64_tr_b16 v[78:79], v4 offset:17664
    ds_read_b128 v[140:143], v0 offset:544
    s_waitcnt lgkmcnt(6)
    v_mfma_f32_32x32x16_bf16 v[168:183], v[68:71], v[164:167], v[168:183]
    s_waitcnt vmcnt(13)
    ds_read_b64_tr_b16 v[80:81], v4 offset:18432
    ds_read_b64_tr_b16 v[82:83], v4 offset:18688
    ds_read_b128 v[144:147], v0 offset:576
    s_waitcnt lgkmcnt(6)
    v_mfma_f32_32x32x16_bf16 v[168:183], v[72:75], v[136:139], v[168:183]
    s_waitcnt vmcnt(12)
    ds_read_b64_tr_b16 v[84:85], v4 offset:19456
    ds_read_b64_tr_b16 v[86:87], v4 offset:19712
    ds_read_b128 v[148:151], v0 offset:608
    s_waitcnt lgkmcnt(6)
    v_mfma_f32_32x32x16_bf16 v[168:183], v[76:79], v[140:143], v[168:183]
    s_waitcnt vmcnt(11)
    ds_read_b64_tr_b16 v[88:89], v4 offset:20480
    ds_read_b64_tr_b16 v[90:91], v4 offset:20736
    ds_read_b128 v[152:155], v0 offset:640
    s_waitcnt lgkmcnt(6)
    v_mfma_f32_32x32x16_bf16 v[168:183], v[80:83], v[144:147], v[168:183]
    s_waitcnt vmcnt(10)
    ds_read_b64_tr_b16 v[92:93], v4 offset:21504
    ds_read_b64_tr_b16 v[94:95], v4 offset:21760
    ds_read_b128 v[156:159], v0 offset:672
    s_waitcnt lgkmcnt(6)
    v_mfma_f32_32x32x16_bf16 v[168:183], v[84:87], v[148:151], v[168:183]
    s_waitcnt vmcnt(9)
    ds_read_b64_tr_b16 v[96:97], v4 offset:22528
    ds_read_b64_tr_b16 v[98:99], v4 offset:22784
    ds_read_b128 v[160:163], v0 offset:704
    s_waitcnt lgkmcnt(6)
    v_mfma_f32_32x32x16_bf16 v[168:183], v[88:91], v[152:155], v[168:183]
    s_waitcnt vmcnt(8)
    ds_read_b64_tr_b16 v[100:101], v4 offset:23552
    ds_read_b64_tr_b16 v[102:103], v4 offset:23808
    ds_read_b128 v[164:167], v0 offset:736
    s_waitcnt lgkmcnt(6)
    v_mfma_f32_32x32x16_bf16 v[168:183], v[92:95], v[156:159], v[168:183]
    s_waitcnt vmcnt(7)
    ds_read_b64_tr_b16 v[104:105], v4 offset:24576
    ds_read_b64_tr_b16 v[106:107], v4 offset:24832
    ds_read_b128 v[136:139], v0 offset:768
    s_waitcnt lgkmcnt(6)
    v_mfma_f32_32x32x16_bf16 v[168:183], v[96:99], v[160:163], v[168:183]
    s_waitcnt vmcnt(6)
    ds_read_b64_tr_b16 v[108:109], v4 offset:0
    ds_read_b64_tr_b16 v[110:111], v4 offset:256
    ds_read_b128 v[140:143], v0 offset:800
    s_waitcnt lgkmcnt(6)
    v_mfma_f32_32x32x16_bf16 v[168:183], v[100:103], v[164:167], v[168:183]
    s_waitcnt vmcnt(5)
    ds_read_b64_tr_b16 v[112:113], v4 offset:1024
    ds_read_b64_tr_b16 v[114:115], v4 offset:1280
    ds_read_b128 v[144:147], v0 offset:832
    s_waitcnt lgkmcnt(6)
    v_mfma_f32_32x32x16_bf16 v[168:183], v[104:107], v[136:139], v[168:183]
    s_waitcnt vmcnt(4)
    ds_read_b64_tr_b16 v[116:117], v4 offset:2048
    ds_read_b64_tr_b16 v[118:119], v4 offset:2304
    ds_read_b128 v[148:151], v0 offset:864
    s_waitcnt lgkmcnt(6)
    v_mfma_f32_32x32x16_bf16 v[168:183], v[108:111], v[140:143], v[168:183]
    s_waitcnt vmcnt(3)
    ds_read_b64_tr_b16 v[120:121], v4 offset:3072
    ds_read_b64_tr_b16 v[122:123], v4 offset:3328
    ds_read_b128 v[152:155], v0 offset:896
    s_waitcnt lgkmcnt(6)
    v_mfma_f32_32x32x16_bf16 v[168:183], v[112:115], v[144:147], v[168:183]
    s_waitcnt vmcnt(2)
    ds_read_b64_tr_b16 v[124:125], v4 offset:4096
    ds_read_b64_tr_b16 v[126:127], v4 offset:4352
    ds_read_b128 v[156:159], v0 offset:928
    s_waitcnt lgkmcnt(6)
    v_mfma_f32_32x32x16_bf16 v[168:183], v[116:119], v[148:151], v[168:183]
    s_waitcnt vmcnt(1)
    ds_read_b64_tr_b16 v[128:129], v4 offset:5120
    ds_read_b64_tr_b16 v[130:131], v4 offset:5376
    ds_read_b128 v[160:163], v0 offset:960
    s_waitcnt lgkmcnt(6)
    v_mfma_f32_32x32x16_bf16 v[168:183], v[120:123], v[152:155], v[168:183]
    s_waitcnt vmcnt(0)
    ds_read_b64_tr_b16 v[132:133], v4 offset:6144
    ds_read_b64_tr_b16 v[134:135], v4 offset:6400
    ds_read_b128 v[164:167], v0 offset:992
    s_waitcnt lgkmcnt(6)
    v_mfma_f32_32x32x16_bf16 v[168:183], v[124:127], v[156:159], v[168:183]
    s_waitcnt lgkmcnt(3)
    v_mfma_f32_32x32x16_bf16 v[168:183], v[128:131], v[160:163], v[168:183]
    s_waitcnt lgkmcnt(0)
    v_mfma_f32_32x32x16_bf16 v[168:183], v[132:135], v[164:167], v[168:183]
    s_nop 11
    v_cvt_pk_bf16_f32 v184, v168, v169
    v_cvt_pk_bf16_f32 v185, v170, v171
    v_cvt_pk_bf16_f32 v186, v172, v173
    v_cvt_pk_bf16_f32 v187, v174, v175
    v_cvt_pk_bf16_f32 v188, v176, v177
    v_cvt_pk_bf16_f32 v189, v178, v179
    v_cvt_pk_bf16_f32 v190, v180, v181
    v_cvt_pk_bf16_f32 v191, v182, v183
    v_lshlrev_b32 v168, 16, v184
    v_and_b32 v169, 0xffff0000, v184
    v_lshlrev_b32 v170, 16, v185
    v_and_b32 v171, 0xffff0000, v185
    v_lshlrev_b32 v172, 16, v186
    v_and_b32 v173, 0xffff0000, v186
    v_lshlrev_b32 v174, 16, v187
    v_and_b32 v175, 0xffff0000, v187
    v_lshlrev_b32 v176, 16, v188
    v_and_b32 v177, 0xffff0000, v188
    v_lshlrev_b32 v178, 16, v189
    v_and_b32 v179, 0xffff0000, v189
    v_lshlrev_b32 v180, 16, v190
    v_and_b32 v181, 0xffff0000, v190
    v_lshlrev_b32 v182, 16, v191
    v_and_b32 v183, 0xffff0000, v191
    v_pk_mul_f32 v[168:169], v[168:169], s[64:65] op_sel_hi:[1,0]
    v_pk_mul_f32 v[170:171], v[170:171], s[64:65] op_sel_hi:[1,0]
    v_pk_mul_f32 v[172:173], v[172:173], s[64:65] op_sel_hi:[1,0]
    v_pk_mul_f32 v[174:175], v[174:175], s[64:65] op_sel_hi:[1,0]
    v_cvt_pk_bf16_f32 v184, v168, v169
    v_cvt_pk_bf16_f32 v185, v170, v171
    v_cvt_pk_bf16_f32 v186, v172, v173
    v_cvt_pk_bf16_f32 v187, v174, v175
    buffer_store_dwordx4 v[184:187], v6, s[32:35], s49 offen offset:0 sc1
    v_pk_mul_f32 v[176:177], v[176:177], s[64:65] op_sel_hi:[1,0]
    v_pk_mul_f32 v[178:179], v[178:179], s[64:65] op_sel_hi:[1,0]
    v_pk_mul_f32 v[180:181], v[180:181], s[64:65] op_sel_hi:[1,0]
    v_pk_mul_f32 v[182:183], v[182:183], s[64:65] op_sel_hi:[1,0]
    v_cvt_pk_bf16_f32 v188, v176, v177
    v_cvt_pk_bf16_f32 v189, v178, v179
    v_cvt_pk_bf16_f32 v190, v180, v181
    v_cvt_pk_bf16_f32 v191, v182, v183
    buffer_store_dwordx4 v[188:191], v6, s[32:35], s49 offen offset:128 sc1
    v_and_b32 v7, 0x3ff, v6
    s_and_b32 s50, s49, 0x7ff
    v_add_u32 v7, s50, v7
    s_lshl_b32 s50, s38, 3
    s_lshl_b32 exec_lo, 0xff, s50
    s_mov_b32 exec_hi, exec_lo
    ds_write_b128 v7, v[184:187] offset:40960
    ds_write_b128 v7, v[188:191] offset:41088
    s_mov_b64 exec, -1
    s_cmp_lg_u32 s36, 3
    s_cbranch_scc1 A_nw2
    s_mov_b32 s40, 0x05040100
    s_mov_b32 s41, 0x07060302
    v_perm_b32 v16, v201, v200, s40
    v_perm_b32 v17, v203, v202, s40
    v_perm_b32 v18, v205, v204, s40
    v_perm_b32 v19, v207, v206, s40
    v_perm_b32 v20, v201, v200, s41
    v_perm_b32 v21, v203, v202, s41
    v_perm_b32 v22, v205, v204, s41
    v_perm_b32 v23, v207, v206, s41
    s_lshl_b32 s62, s2, 11
    s_add_u32 s62, s62, 0x600000
    buffer_store_dwordx4 v[16:19], v2, s[32:35], s62 offen sc1
    buffer_store_dwordx4 v[20:23], v2, s[32:35], s62 offen offset:1024 sc1
    v_lshlrev_b32 v7, 15, v1
    v_mov_b32 v24, 0
    v_mov_b32 v25, 0
    s_lshl_b32 s63, s2, 7
    s_add_u32 s63, s63, 0x500000
    s_mov_b64 exec, 0x103
    buffer_store_dwordx2 v[24:25], v7, s[32:35], s63 offen sc1
    s_mov_b64 exec, -1
A_nw2:
J_in:
    s_setprio 0
    s_mov_b32 s28, s14
    s_and_b32 s29, s15, 0xffff
    s_mov_b32 s30, 0x800000
    s_mov_b32 s31, 0x20000
    s_and_b32 s46, s2, 7
    s_lshl_b32 s46, s46, 15
    s_lshl_b32 s51, s36, 12
    s_add_u32 s46, s46, s51
    s_add_u32 s9, s46, 0x580000
    v_lshlrev_b32 v154, 7, v1
    v_mov_b32 v116, 0
    s_load_dwordx2 s[4:5], s[0:1], 0
    s_load_dwordx4 s[12:15], s[0:1], 48
    s_load_dwordx4 s[60:63], s[0:1], 64
    s_load_dwordx2 s[10:11], s[0:1], 80
    s_mov_b32 s32, s36
    s_lshl2_add_u32 s50, s37, s38
    s_lshl_b32 s33, s38, 1
    v_lshlrev_b32 v3, 4, v1
    s_lshl_b32 s34, s50, 13
    s_lshl_b32 s48, s32, 10
    s_add_u32 s40, s48, s34
    s_lshl_b32 s36, s32, 13
    s_add_u32 s36, s36, 0x680000
    s_add_u32 s37, s36, 4096
    s_xor_b32 s35, s32, s33
    s_lshl_b32 s35, s35, 10
    s_add_u32 s35, s35, s34
    s_add_u32 s35, s35, 0x0
    v_and_b32 v136, 31, v1
    v_lshrrev_b32 v137, 5, v1
    v_lshlrev_b32 v0, 4, v136
    s_add_u32 s38, s36, 0x10000
    s_add_u32 s39, s38, 4096
    s_waitcnt lgkmcnt(0)
    s_mov_b32 s16, s4
    s_and_b32 s17, s5, 0xffff
    s_mov_b32 s18, 0x200000
    s_mov_b32 s19, 0x20000
    s_mov_b32 s20, s12
    s_and_b32 s21, s13, 0xffff
    s_mov_b32 s22, 0x400
    s_mov_b32 s23, 0x20000
    s_mov_b32 s24, s10
    s_and_b32 s25, s11, 0xffff
    s_mov_b32 s26, 0x200000
    s_mov_b32 s27, 0x20000
    s_mov_b32 s8, s2
    s_lshl_b32 s41, s32, 16
    s_add_u32 s41, s41, 0x600000
    s_lshl_b32 s43, s33, 13
    s_add_u32 s41, s41, s43
    s_xor_b32 s43, s32, s33
    s_mul_i32 s42, s32, 13312
    s_add_u32 s42, s42, 49152
    s_mov_b32 s33, 0
    s_and_b32 s44, s2, 7
    s_lshr_b32 s45, s2, 3
    s_mul_i32 s55, s44, 6
    s_add_u32 s55, s55, s45
    s_mov_b32 s54, 0
    s_cmp_lt_u32 s45, 6
    s_cselect_b32 s46, s55, 99
    s_cmp_lt_u32 s46, 43
    s_cselect_b32 s54, 1, 0
    s_bitcmp1_b32 s32, 0
    s_cselect_b32 s14, s60, s14
    s_cselect_b32 s15, s61, s15
    s_cmp_eq_u32 s32, 2
    s_cselect_b32 s4, s62, s14
    s_cselect_b32 s5, s63, s15
    s_mov_b32 s4, s4
    s_and_b32 s5, s5, 0xffff
    s_mov_b32 s6, 0x158000
    s_mov_b32 s7, 0x20000
    s_lshl_b32 s46, s45, 6
    v_add_u32 v10, s46, v1
    v_lshrrev_b32 v248, 2, v10
    v_mul_u32_u24 v248, 2752, v248
    v_and_b32 v11, 3, v1
    v_lshlrev_b32 v11, 7, v11
    v_min_u32 v11, 380, v11
    v_add_u32 v248, v248, v11
    v_lshlrev_b32 v10, 10, v10
    s_mul_i32 s50, s44, 384
    s_lshl_b32 s51, s44, 7
    s_cmp_eq_u32 s32, 2
    s_cselect_b32 s50, s51, s50
    s_cselect_b64 vcc, -1, 0
    s_cmp_gt_u32 s32, 2
    s_cselect_b32 s12, 0x40000000, s50
    v_cndmask_b32 v248, v248, v10, vcc
    s_lshr_b32 s46, s32, 1
    s_mul_i32 s53, s46, 352256
    s_mov_b32 s52, 2752
    s_lshr_b32 s46, s2, 4
    s_cmp_eq_u32 s46, 4
    s_cbranch_scc0 B_nd
    s_mov_b32 s54, 2
    s_lshl_b32 s55, s44, 1
    s_and_b32 s45, s45, 1
    s_add_u32 s55, s55, s45
    s_mov_b32 s14, s62
    s_mov_b32 s15, s63
    s_mul_i32 s53, s32, 196608
    s_movk_i32 s52, 1024
B_nd:
    s_mov_b32 s56, s14
    s_and_b32 s57, s15, 0xffff
    s_mov_b32 s58, 0x158000
    s_mov_b32 s59, 0x20000
    s_lshl_b32 s46, s55, 6
    s_add_u32 s53, s53, s46
    s_cmp_eq_u32 s54, 0
    s_cselect_b32 s53, 0x40000000, s53
    s_lshl_b32 s46, s2, 2
    s_add_u32 s46, s46, s32
    s_lshl_b32 s46, s46, 7
    s_add_u32 s46, s46, 0x5c0000
    s_cmp_lt_u32 s32, 4
    s_cselect_b32 s14, s46, 0x40000000
    s_and_b32 s46, s2, 0xe7
    s_lshr_b32 s51, s43, 1
    s_lshl3_add_u32 s46, s51, s46
    s_and_b32 s51, s43, 1
    s_lshl1_add_u32 s46, s46, s51
    s_lshl_b32 s46, s46, 8
    s_add_u32 s15, s46, 0x5c0000
    v_bfe_u32 v241, v1, 4, 1
    v_lshlrev_b32 v241, 7, v241
    v_add_u32 v241, s15, v241
    s_sub_u32 s46, s9, 0x380000
    v_add_u32 v240, s46, v154
    v_cmp_gt_u32 vcc, 32, v1
    s_nop 1
    v_cndmask_b32 v241, v241, v240, vcc
    s_waitcnt lgkmcnt(0)
    s_barrier
    s_mov_b64 exec, 0xffffffff
    buffer_load_dword v156, v154, s[28:31], s9 offen sc1
    s_mov_b64 exec, -1
    v_lshl_add_u32 v4, v137, 9, v0
    v_add_u32 v4, s42, v4
    v_and_b32 v10, 27, v136
    v_cmp_eq_u32 vcc, 16, v10
    v_mov_b32 v10, 17424
    v_mov_b32 v11, 17408
    v_cndmask_b32 v11, v10, v11, vcc
    v_cmp_gt_u32 vcc, 16, v136
    s_nop 1
    v_cndmask_b32 v4, v11, v4, vcc
    s_and_b32 s44, s32, 3
    v_lshrrev_b32 v10, 3, v136
    v_lshlrev_b32 v5, 8, v10
    v_and_b32 v10, 7, v136
    v_lshl_add_u32 v5, v10, 4, v5
    v_lshl_add_u32 v5, v137, 3, v5
    s_lshr_b32 s45, s44, 1
    s_lshl_b32 s45, s45, 7
    s_and_b32 s46, s44, 1
    s_lshl_b32 s46, s46, 2
    s_add_u32 s45, s45, s46
    v_add_u32 v5, s45, v5
    s_lshl_b32 s45, s44, 12
    v_add_u32 v6, s45, v3
    s_lshr_b32 s45, s32, 1
    s_lshl_b32 s45, s45, 10
    s_and_b32 s46, s32, 1
    s_lshl_b32 s46, s46, 3
    s_add_u32 s45, s45, s46
    v_add_u32 v14, s45, v3
    s_lshr_b32 s45, s32, 2
    s_lshl_b32 s45, s45, 9
    s_lshl_b32 s46, s44, 2
    s_add_u32 s45, s45, s46
    v_add_u32 v15, s45, v0
    v_and_b32 v7, 7, v1
    v_lshlrev_b32 v7, 4, v7
    v_lshrrev_b32 v10, 4, v1
    v_lshl_add_u32 v7, v10, 7, v7
    v_and_b32 v10, 8, v1
    v_cmp_eq_u32 vcc, 0, v10
    v_mov_b32 v10, 119040
    s_nop 0
    v_cndmask_b32 v7, v10, v7, vcc
    v_lshrrev_b32 v8, 2, v1
    v_mul_lo_u32 v8, s52, v8
    v_and_b32 v11, 3, v1
    v_lshl_add_u32 v8, v11, 4, v8
    v_mov_b32 v2, 155648
    v_mov_b32 v9, 0xdddd
    v_mov_b32 v116, 0
    v_mov_b32 v117, 0
    v_mov_b32 v118, 0
    v_mov_b32 v119, 0
    s_lshl_b32 s49, s32, 9
    v_lshrrev_b32 v10, 3, v1
    v_lshlrev_b32 v249, 13, v10
    v_and_b32 v11, 7, v1
    v_lshl_add_u32 v249, v11, 4, v249
    v_cmp_gt_u32 vcc, 4, v10
    v_mov_b32 v10, 0x40000000
    s_nop 0
    v_cndmask_b32 v249, v10, v249, vcc
    s_lshl_b32 s45, s55, 7
    s_add_u32 s45, s45, 0x548000
    s_lshl_b32 s46, s54, 3
    s_add_u32 s46, s46, s32
    s_cmp_eq_u32 s46, 10
    s_cselect_b32 s45, s45, 0x40000000
    s_lshl_b32 s46, s8, 11
    s_add_u32 s46, s46, s48
    s_add_u32 s46, s46, 0x400000
    s_cmp_lt_u32 s32, 2
    s_cselect_b32 s34, s46, s45
    s_cselect_b64 vcc, -1, 0
    v_cndmask_b32 v249, v249, v3, vcc
    v_mov_b32 v252, -1
    v_mov_b32 v253, -1
    v_mov_b32 v254, -1
    v_mov_b32 v255, -1
    v_add_u32 v10, s48, v3
    v_add_u32 v11, s49, v0
    v_and_b32 v250, 8, v1
    v_lshlrev_b32 v250, 3, v250
    v_and_b32 v251, 48, v1
    v_add_u32 v250, v250, v251
    v_and_b32 v251, 7, v1
    v_lshl_add_u32 v251, v251, 10, v250
    s_sub_u32 s40, s40, s48
    s_lshl_b32 s10, s32, 7
    s_add_u32 s40, s40, s10
    v_mov_b32 v12, 0
    v_mov_b32 v13, 0x7f800000
    v_mfma_f32_32x32x16_bf16 v[168:183], v[116:119], v[116:119], 0
    v_mfma_f32_32x32x16_bf16 v[184:199], v[116:119], v[116:119], 0
    s_cmp_lg_u32 s32, 6
    s_cbranch_scc1 B_pi0
    ds_write_b32 v2, v116
    v_lshlrev_b32 v120, 4, v0
    v_mov_b32 v124, 0x45804580
    v_mov_b32 v125, 0x45804580
    v_mov_b32 v126, 0x45804580
    v_mov_b32 v127, 0x45804580
    s_mov_b64 exec, 0x33333333
    ds_write_b128 v120, v[124:127] offset:17408
    ds_write_b128 v120, v[116:119] offset:17424
    v_lshl_add_u32 v120, v120, 1, v2
    s_mov_b64 exec, 0x3
    ds_write_b128 v120, v[116:119] offset:2304
    ds_write_b128 v120, v[116:119] offset:3328
    s_mov_b64 exec, -1
B_pi0:
    v_mov_b32 v160, s3
    s_mov_b32 s46, 1048576
    s_mov_b64 exec, 0xffffffff
J_wt:
    s_waitcnt vmcnt(0)
    v_cmp_ne_u32 vcc, s3, v156
    s_mov_b64 exec, vcc
    s_cbranch_execz J_go
    buffer_load_dword v156, v154, s[28:31], s9 offen sc1
    s_sub_u32 s46, s46, 1
    s_cbranch_scc0 J_wt
J_go:
    s_mov_b64 exec, -1
    buffer_load_dwordx4 v[16:19], v3, s[28:31], s36 offen offset:0 sc1
    buffer_load_dwordx4 v[20:23], v3, s[28:31], s36 offen offset:1024 sc1
    s_add_u32 m0, s42, 0
    s_nop 0
    buffer_load_dwordx4 v3, s[28:31], s38 offen offset:0 sc1 lds
    buffer_load_dwordx4 v[24:27], v3, s[28:31], s36 offen offset:2048 sc1
    buffer_load_dwordx4 v3, s[28:31], s38 offen offset:1024 sc1 lds
    buffer_load_dwordx4 v[28:31], v3, s[28:31], s36 offen offset:3072 sc1
    buffer_load_dwordx4 v3, s[28:31], s38 offen offset:2048 sc1 lds
    s_mov_b64 exec, 0xff
    buffer_store_dwordx4 v[160:163], v3, s[28:31], s14 offen sc1
    s_mov_b64 exec, -1
    s_cmp_lg_u32 s32, 3
    s_cbranch_scc1 B_nf2
    v_lshrrev_b32 v152, 3, v1
    v_lshlrev_b32 v152, 15, v152
    v_and_b32 v153, 7, v1
    v_lshl_add_u32 v152, v153, 4, v152
    s_lshl_b32 s46, s2, 7
    s_add_u32 s46, s46, 0x200000
    buffer_store_dwordx4 v[160:163], v152, s[28:31], s46 offen sc1
    s_mov_b64 exec, -1
B_nf2:
    s_cmp_ge_u32 s32, 2
    s_cbranch_scc1 B_start
    s_setprio 3
    ds_read_b128 v[112:115], v10 offset:40960
    s_waitcnt vmcnt(6)
    s_waitcnt lgkmcnt(0)
    v_mfma_f32_32x32x16_bf16 v[136:151], v[16:19], v[112:115], 0
    v_mfma_f32_32x32x16_bf16 v[152:167], v[20:23], v[112:115], 0
    s_nop 10
    v_max_f32 v216, v136, v137
    v_max3_f32 v216, v216, v138, v139
    v_max3_f32 v216, v216, v140, v141
    v_max3_f32 v216, v216, v142, v143
    v_max3_f32 v216, v216, v144, v145
    v_max3_f32 v216, v216, v146, v147
    v_max3_f32 v216, v216, v148, v149
    v_max3_f32 v216, v216, v150, v151
    v_max3_f32 v216, v216, v152, v153
    v_max3_f32 v216, v216, v154, v155
    v_max3_f32 v216, v216, v156, v157
    v_max3_f32 v216, v216, v158, v159
    v_max3_f32 v216, v216, v160, v161
    v_max3_f32 v216, v216, v162, v163
    v_max3_f32 v216, v216, v164, v165
    v_max3_f32 v216, v216, v166, v167
    v_mov_b32 v217, v216
    s_nop 1
    v_permlane32_swap_b32 v216, v217
    v_max_f32 v219, v216, v217
    v_sub_f32 v216, 0xc2c80000, v219
    v_sub_f32 v217, 0xc2c80000, v219
    v_sub_f32 v218, 0xc2c80000, v219
    v_sub_f32 v219, 0xc2c80000, v219
    ds_write_b128 v11, v[216:219] offset:34816
    s_setprio 0
B_start:
    s_waitcnt lgkmcnt(0)
    s_barrier
    ds_read_b128 v[112:115], v3 offset:40960
    ds_read_b128 v[120:123], v0 offset:34816
    ds_read_b128 v[124:127], v0 offset:34816
    ds_read_b128 v[128:131], v0 offset:34816
    ds_read_b128 v[132:135], v0 offset:34816
    s_lshl3_add_u32 s46, s2, s32
    s_cmp_lg_u32 s46, 7
    s_cbranch_scc1 B_nt
    v_mov_b32 v232, s3
    s_mov_b32 s46, 0x5e0000
    s_mov_b64 exec, 1
    buffer_store_dword v232, off, s[28:31], s46
    s_mov_b64 exec, -1
B_nt:
    s_waitcnt vmcnt(7)
    s_waitcnt lgkmcnt(0)
    v_mfma_f32_32x32x16_bf16 v[136:151], v[16:19], v[112:115], v[120:135]
    s_waitcnt vmcnt(5)
    ds_read_b128 v[48:51], v4 offset:0
    ds_read_b128 v[52:55], v4 offset:256
    s_nop 8
    v_exp_f32 v136, v136
    v_exp_f32 v137, v137
    s_waitcnt vmcnt(6)
    buffer_load_dwordx4 v[32:35], v3, s[28:31], s37 offen offset:0 sc1
    v_exp_f32 v138, v138
    v_exp_f32 v139, v139
    v_exp_f32 v140, v140
    v_mfma_f32_32x32x16_bf16 v[152:167], v[20:23], v[112:115], v[120:135]
    s_waitcnt lgkmcnt(0)
    buffer_load_dwordx4 v3, s[28:31], s38 offen offset:3072 sc1 lds
    v_exp_f32 v141, v141
    v_exp_f32 v142, v142
    v_exp_f32 v143, v143
    v_exp_f32 v144, v144
    v_exp_f32 v145, v145
    v_smfmac_f32_32x32x32_bf16 v[168:183], v[48:51], v[136:143], v9
    s_waitcnt vmcnt(5)
    ds_read_b128 v[56:59], v4 offset:1024
    ds_read_b128 v[60:63], v4 offset:1280
    s_setprio 1
    v_exp_f32 v146, v146
    v_exp_f32 v147, v147
    v_exp_f32 v148, v148
    v_exp_f32 v149, v149
    v_exp_f32 v150, v150
    v_exp_f32 v151, v151
    v_exp_f32 v152, v152
    v_exp_f32 v153, v153
    v_smfmac_f32_32x32x32_bf16 v[168:183], v[52:55], v[144:151], v9
    s_waitcnt vmcnt(6)
    buffer_load_dwordx4 v[36:39], v3, s[28:31], s37 offen offset:1024 sc1
    v_exp_f32 v154, v154
    v_exp_f32 v155, v155
    v_exp_f32 v156, v156
    v_mfma_f32_32x32x16_bf16 v[136:151], v[24:27], v[112:115], v[120:135]
    s_waitcnt lgkmcnt(0)
    s_add_u32 m0, s42, 4096
    s_nop 0
    buffer_load_dwordx4 v3, s[28:31], s39 offen offset:0 sc1 lds
    v_exp_f32 v157, v157
    v_exp_f32 v158, v158
    v_exp_f32 v159, v159
    v_exp_f32 v160, v160
    v_exp_f32 v161, v161
    v_smfmac_f32_32x32x32_bf16 v[168:183], v[56:59], v[152:159], v9
    s_waitcnt vmcnt(5)
    ds_read_b128 v[64:67], v4 offset:2048
    ds_read_b128 v[68:71], v4 offset:2304
    s_setprio 0
    v_exp_f32 v162, v162
    v_exp_f32 v163, v163
    v_exp_f32 v164, v164
    v_exp_f32 v165, v165
    v_exp_f32 v166, v166
    v_exp_f32 v167, v167
    v_exp_f32 v136, v136
    v_exp_f32 v137, v137
    v_smfmac_f32_32x32x32_bf16 v[168:183], v[60:63], v[160:167], v9
    s_waitcnt vmcnt(6)
    buffer_load_dwordx4 v[40:43], v3, s[28:31], s37 offen offset:2048 sc1
    v_exp_f32 v138, v138
    v_exp_f32 v139, v139
    v_exp_f32 v140, v140
    v_mfma_f32_32x32x16_bf16 v[152:167], v[28:31], v[112:115], v[120:135]
    s_waitcnt lgkmcnt(0)
    buffer_load_dwordx4 v3, s[28:31], s39 offen offset:1024 sc1 lds
    v_exp_f32 v141, v141
    v_exp_f32 v142, v142
    v_exp_f32 v143, v143
    v_exp_f32 v144, v144
    v_exp_f32 v145, v145
    v_smfmac_f32_32x32x32_bf16 v[168:183], v[64:67], v[136:143], v9
    s_waitcnt vmcnt(4)
    ds_read_b128 v[72:75], v4 offset:3072
    ds_read_b128 v[76:79], v4 offset:3328
    s_setprio 3
    v_exp_f32 v146, v146
    v_exp_f32 v147, v147
    v_exp_f32 v148, v148
    v_exp_f32 v149, v149
    v_exp_f32 v150, v150
    v_exp_f32 v151, v151
    v_exp_f32 v152, v152
    v_exp_f32 v153, v153
    v_smfmac_f32_32x32x32_bf16 v[168:183], v[68:71], v[144:151], v9
    s_waitcnt vmcnt(5)
    buffer_load_dwordx4 v[44:47], v3, s[28:31], s37 offen offset:3072 sc1
    v_exp_f32 v154, v154
    v_exp_f32 v155, v155
    v_exp_f32 v156, v156
    v_mfma_f32_32x32x16_bf16 v[136:151], v[32:35], v[112:115], v[120:135]
    s_waitcnt lgkmcnt(0)
    buffer_load_dwordx4 v3, s[28:31], s39 offen offset:2048 sc1 lds
    v_exp_f32 v157, v157
    v_exp_f32 v158, v158
    v_exp_f32 v159, v159
    v_exp_f32 v160, v160
    v_exp_f32 v161, v161
    v_smfmac_f32_32x32x32_bf16 v[168:183], v[72:75], v[152:159], v9
    s_waitcnt vmcnt(4)
    ds_read_b128 v[80:83], v4 offset:4096
    ds_read_b128 v[84:87], v4 offset:4352
    v_exp_f32 v162, v162
    v_exp_f32 v163, v163
    v_exp_f32 v164, v164
    v_exp_f32 v165, v165
    v_exp_f32 v166, v166
    v_exp_f32 v167, v167
    v_exp_f32 v136, v136
    v_exp_f32 v137, v137
    v_smfmac_f32_32x32x32_bf16 v[168:183], v[76:79], v[160:167], v9
    s_waitcnt vmcnt(5)
    v_exp_f32 v138, v138
    v_exp_f32 v139, v139
    v_exp_f32 v140, v140
    v_mfma_f32_32x32x16_bf16 v[152:167], v[36:39], v[112:115], v[120:135]
    s_waitcnt lgkmcnt(0)
    buffer_load_dwordx4 v3, s[28:31], s39 offen offset:3072 sc1 lds
    v_exp_f32 v141, v141
    v_exp_f32 v142, v142
    v_exp_f32 v143, v143
    v_exp_f32 v144, v144
    v_exp_f32 v145, v145
    v_smfmac_f32_32x32x32_bf16 v[168:183], v[80:83], v[136:143], v9
    s_waitcnt vmcnt(3)
    ds_read_b128 v[88:91], v4 offset:5120
    ds_read_b128 v[92:95], v4 offset:5376
    v_exp_f32 v146, v146
    v_exp_f32 v147, v147
    v_exp_f32 v148, v148
    v_exp_f32 v149, v149
    buffer_load_dword v240, v241, s[28:31], 0 offen sc1
    v_exp_f32 v150, v150
    v_exp_f32 v151, v151
    v_exp_f32 v152, v152
    v_exp_f32 v153, v153
    v_smfmac_f32_32x32x32_bf16 v[168:183], v[84:87], v[144:151], v9
    s_waitcnt vmcnt(5)
    v_exp_f32 v154, v154
    v_exp_f32 v155, v155
    v_exp_f32 v156, v156
    v_mfma_f32_32x32x16_bf16 v[136:151], v[40:43], v[112:115], v[120:135]
    s_waitcnt lgkmcnt(0)
    v_exp_f32 v157, v157
    v_exp_f32 v158, v158
    v_exp_f32 v159, v159
    v_exp_f32 v160, v160
    v_exp_f32 v161, v161
    v_smfmac_f32_32x32x32_bf16 v[168:183], v[88:91], v[152:159], v9
    s_waitcnt vmcnt(2)
    ds_read_b128 v[96:99], v4 offset:6144
    ds_read_b128 v[100:103], v4 offset:6400
    s_setprio 2
    v_exp_f32 v162, v162
    v_exp_f32 v163, v163
    v_exp_f32 v164, v164
    v_exp_f32 v165, v165
    v_exp_f32 v166, v166
    v_exp_f32 v167, v167
    v_exp_f32 v136, v136
    v_exp_f32 v137, v137
    v_smfmac_f32_32x32x32_bf16 v[168:183], v[92:95], v[160:167], v9
    s_waitcnt vmcnt(3)
    v_exp_f32 v138, v138
    v_exp_f32 v139, v139
    v_exp_f32 v140, v140
    v_mfma_f32_32x32x16_bf16 v[152:167], v[44:47], v[112:115], v[120:135]
    s_waitcnt lgkmcnt(0)
    ds_read_b128 v[112:115], v3 offset:41984
    v_exp_f32 v141, v141
    v_exp_f32 v142, v142
    v_exp_f32 v143, v143
    v_exp_f32 v144, v144
    v_exp_f32 v145, v145
    v_smfmac_f32_32x32x32_bf16 v[168:183], v[96:99], v[136:143], v9
    s_waitcnt vmcnt(1)
    ds_read_b128 v[104:107], v4 offset:7168
    ds_read_b128 v[108:111], v4 offset:7424
    ds_read_b128 v[120:123], v0 offset:35328
    ds_read_b128 v[124:127], v0 offset:35328
    ds_read_b128 v[128:131], v0 offset:35328
    ds_read_b128 v[132:135], v0 offset:35328
    v_exp_f32 v146, v146
    v_exp_f32 v147, v147
    v_exp_f32 v148, v148
    v_exp_f32 v149, v149
    s_waitcnt vmcnt(0)
    v_cmp_eq_u32 vcc, s3, v240
    s_cmp_eq_u64 vcc, -1
    s_cbranch_scc0 B_qw
B_qr:
    buffer_load_dwordx4 v[244:247], v3, s[28:31], s35 offen sc1
    v_exp_f32 v150, v150
    v_exp_f32 v151, v151
    v_exp_f32 v152, v152
    v_exp_f32 v153, v153
    v_smfmac_f32_32x32x32_bf16 v[168:183], v[100:103], v[144:151], v9
    v_exp_f32 v154, v154
    v_exp_f32 v155, v155
    v_exp_f32 v156, v156
    v_exp_f32 v157, v157
    v_exp_f32 v158, v158
    s_waitcnt lgkmcnt(0)
    v_mfma_f32_32x32x16_bf16 v[136:151], v[16:19], v[112:115], v[120:135]
    s_waitcnt lgkmcnt(0)
    v_exp_f32 v159, v159
    v_exp_f32 v160, v160
    v_exp_f32 v161, v161
    v_exp_f32 v162, v162
    v_smfmac_f32_32x32x32_bf16 v[168:183], v[104:107], v[152:159], v9
    s_xor_b32 s43, s41, 0
    buffer_load_dwordx4 v[216:219], v3, s[28:31], s43 offen offset:0 sc1
    v_exp_f32 v163, v163
    v_exp_f32 v164, v164
    v_exp_f32 v165, v165
    v_exp_f32 v166, v166
    v_exp_f32 v167, v167
    v_exp_f32 v136, v136
    v_exp_f32 v137, v137
    v_smfmac_f32_32x32x32_bf16 v[168:183], v[108:111], v[160:167], v9
    v_exp_f32 v138, v138
    v_exp_f32 v139, v139
    v_exp_f32 v140, v140
    v_mfma_f32_32x32x16_bf16 v[152:167], v[20:23], v[112:115], v[120:135]
    buffer_load_dwordx4 v[220:223], v3, s[28:31], s43 offen offset:1024 sc1
    v_exp_f32 v141, v141
    v_exp_f32 v142, v142
    v_exp_f32 v143, v143
    v_exp_f32 v144, v144
    v_exp_f32 v145, v145
    v_smfmac_f32_32x32x32_bf16 v[184:199], v[48:51], v[136:143], v9
    s_setprio 1
    buffer_load_dwordx4 v[224:227], v3, s[28:31], s43 offen offset:2048 sc1
    v_exp_f32 v146, v146
    v_exp_f32 v147, v147
    v_exp_f32 v148, v148
    v_exp_f32 v149, v149
    ds_write_b64 v14, v[168:169] offset:0
    v_exp_f32 v150, v150
    v_exp_f32 v151, v151
    s_waitcnt vmcnt(3)
    v_mfma_f32_32x32x16_bf16 v[200:215], v[16:19], v[244:247], 0
    ds_write_b128 v10, v[244:247] offset:40960
    v_exp_f32 v152, v152
    v_exp_f32 v153, v153
    v_smfmac_f32_32x32x32_bf16 v[184:199], v[52:55], v[144:151], v9
    ds_write_b64 v14, v[170:171] offset:4096
    ds_write_b64 v14, v[172:173] offset:8192
    v_exp_f32 v154, v154
    v_exp_f32 v155, v155
    v_exp_f32 v156, v156
    v_mfma_f32_32x32x16_bf16 v[136:151], v[24:27], v[112:115], v[120:135]
    ds_write_b64 v14, v[174:175] offset:12288
    v_exp_f32 v157, v157
    v_exp_f32 v158, v158
    v_exp_f32 v159, v159
    v_exp_f32 v160, v160
    v_exp_f32 v161, v161
    v_smfmac_f32_32x32x32_bf16 v[184:199], v[56:59], v[152:159], v9
    ds_write_b32 v15, v176 offset:16384
    s_setprio 0
    v_max_f32 v240, v200, v201
    v_max3_f32 v240, v240, v202, v203
    v_max3_f32 v240, v240, v204, v205
    v_max3_f32 v240, v240, v206, v207
    v_max3_f32 v240, v240, v208, v209
    v_max3_f32 v240, v240, v210, v211
    v_max3_f32 v240, v240, v212, v213
    v_max3_f32 v240, v240, v214, v215
    v_mfma_f32_32x32x16_bf16 v[200:215], v[20:23], v[244:247], 0
    v_exp_f32 v162, v162
    v_exp_f32 v163, v163
    v_exp_f32 v164, v164
    v_exp_f32 v165, v165
    buffer_load_dwordx4 v[228:231], v3, s[28:31], s43 offen offset:3072 sc1
    v_exp_f32 v166, v166
    v_exp_f32 v167, v167
    v_exp_f32 v136, v136
    v_exp_f32 v137, v137
    v_smfmac_f32_32x32x32_bf16 v[184:199], v[60:63], v[160:167], v9
    v_exp_f32 v138, v138
    v_exp_f32 v139, v139
    v_exp_f32 v140, v140
    v_mfma_f32_32x32x16_bf16 v[152:167], v[28:31], v[112:115], v[120:135]
    v_max3_f32 v240, v240, v200, v201
    v_max3_f32 v240, v240, v202, v203
    v_max3_f32 v240, v240, v204, v205
    v_max3_f32 v240, v240, v206, v207
    v_max3_f32 v240, v240, v208, v209
    v_max3_f32 v240, v240, v210, v211
    v_max3_f32 v240, v240, v212, v213
    v_max3_f32 v240, v240, v214, v215
    v_mov_b32 v241, v240
    s_nop 1
    v_permlane32_swap_b32 v240, v241
    v_max_f32 v243, v240, v241
    v_sub_f32 v240, 0xc2c80000, v243
    v_sub_f32 v241, 0xc2c80000, v243
    v_sub_f32 v242, 0xc2c80000, v243
    v_sub_f32 v243, 0xc2c80000, v243
    s_cmp_lg_u32 s33, 0
    s_cbranch_scc1 B_r1
    ds_write_b128 v11, v[240:243] offset:34816
B_r1:
    v_exp_f32 v141, v141
    v_exp_f32 v142, v142
    v_exp_f32 v143, v143
    v_exp_f32 v144, v144
    v_exp_f32 v145, v145
    v_smfmac_f32_32x32x32_bf16 v[184:199], v[64:67], v[136:143], v9
    s_waitcnt lgkmcnt(0)
    s_barrier
    s_setprio 3
    v_exp_f32 v146, v146
    v_exp_f32 v147, v147
    v_exp_f32 v148, v148
    v_exp_f32 v149, v149
    v_exp_f32 v150, v150
    v_exp_f32 v151, v151
    v_exp_f32 v152, v152
    v_exp_f32 v153, v153
    v_smfmac_f32_32x32x32_bf16 v[184:199], v[68:71], v[144:151], v9
    ds_read_b128 v[232:235], v0 offset:16384
    ds_read_b128 v[236:239], v0 offset:16896
    v_exp_f32 v154, v154
    v_exp_f32 v155, v155
    v_exp_f32 v156, v156
    v_mfma_f32_32x32x16_bf16 v[136:151], v[32:35], v[112:115], v[120:135]
    ds_read_b128 v[168:171], v6 offset:0
    s_cmp_lg_u32 s33, 0
    s_cbranch_scc1 B_r2
    buffer_load_dword v248, v248, s[4:7], s12 offen
    buffer_store_dwordx4 v[252:255], v249, s[28:31], s34 offen sc1
B_r2:
    v_exp_f32 v157, v157
    v_exp_f32 v158, v158
    v_exp_f32 v159, v159
    v_exp_f32 v160, v160
    v_exp_f32 v161, v161
    v_smfmac_f32_32x32x32_bf16 v[184:199], v[72:75], v[152:159], v9
    ds_read_b128 v[172:175], v6 offset:1024
    v_exp_f32 v162, v162
    v_exp_f32 v163, v163
    v_exp_f32 v164, v164
    v_exp_f32 v165, v165
    v_exp_f32 v166, v166
    v_exp_f32 v167, v167
    v_exp_f32 v136, v136
    v_exp_f32 v137, v137
    v_smfmac_f32_32x32x32_bf16 v[184:199], v[76:79], v[160:167], v9
    ds_read_b128 v[176:179], v6 offset:2048
    ds_read_b128 v[180:183], v6 offset:3072
    v_exp_f32 v138, v138
    v_exp_f32 v139, v139
    v_exp_f32 v140, v140
    v_mfma_f32_32x32x16_bf16 v[152:167], v[36:39], v[112:115], v[120:135]
    v_exp_f32 v141, v141
    v_exp_f32 v142, v142
    v_exp_f32 v143, v143
    v_exp_f32 v144, v144
    v_exp_f32 v145, v145
    v_smfmac_f32_32x32x32_bf16 v[184:199], v[80:83], v[136:143], v9
    s_waitcnt lgkmcnt(0)
    v_exp_f32 v146, v146
    v_exp_f32 v147, v147
    v_exp_f32 v148, v148
    v_exp_f32 v149, v149
    v_exp_f32 v150, v150
    v_exp_f32 v151, v151
    s_cmp_ge_u32 s32, 4
    s_cbranch_scc1 B_young
    v_exp_f32 v152, v152
    v_exp_f32 v153, v153
    v_smfmac_f32_32x32x32_bf16 v[184:199], v[84:87], v[144:151], v9
    v_exp_f32 v154, v154
    v_exp_f32 v155, v155
    v_exp_f32 v156, v156
    v_mfma_f32_32x32x16_bf16 v[136:151], v[40:43], v[112:115], v[120:135]
    v_exp_f32 v157, v157
    v_exp_f32 v158, v158
    v_exp_f32 v159, v159
    v_exp_f32 v160, v160
    v_exp_f32 v161, v161
    v_smfmac_f32_32x32x32_bf16 v[184:199], v[88:91], v[152:159], v9
    s_setprio 2
    v_exp_f32 v162, v162
    v_exp_f32 v163, v163
    v_exp_f32 v164, v164
    v_exp_f32 v165, v165
    v_exp_f32 v166, v166
    v_exp_f32 v167, v167
    v_exp_f32 v136, v136
    v_exp_f32 v137, v137
    v_smfmac_f32_32x32x32_bf16 v[184:199], v[92:95], v[160:167], v9
    v_exp_f32 v138, v138
    v_exp_f32 v139, v139
    v_exp_f32 v140, v140
    v_mfma_f32_32x32x16_bf16 v[152:167], v[44:47], v[112:115], v[120:135]
    ds_read_b128 v[112:115], v3 offset:43008
    v_exp_f32 v141, v141
    v_exp_f32 v142, v142
    v_exp_f32 v143, v143
    v_exp_f32 v144, v144
    v_exp_f32 v145, v145
    v_smfmac_f32_32x32x32_bf16 v[184:199], v[96:99], v[136:143], v9
    ds_read_b128 v[120:123], v0 offset:35840
    ds_read_b128 v[124:127], v0 offset:35840
    ds_read_b128 v[128:131], v0 offset:35840
    ds_read_b128 v[132:135], v0 offset:35840
    v_exp_f32 v146, v146
    v_exp_f32 v147, v147
    v_exp_f32 v148, v148
    v_exp_f32 v149, v149
    v_exp_f32 v150, v150
    v_exp_f32 v151, v151
    v_mfma_f32_32x32x16_bf16 v[168:183], v[116:119], v[116:119], 0
    v_exp_f32 v152, v152
    v_exp_f32 v153, v153
    v_smfmac_f32_32x32x32_bf16 v[184:199], v[100:103], v[144:151], v9
    v_exp_f32 v154, v154
    v_exp_f32 v155, v155
    v_exp_f32 v156, v156
    v_exp_f32 v157, v157
    v_exp_f32 v158, v158
    s_waitcnt lgkmcnt(0)
    v_mfma_f32_32x32x16_bf16 v[136:151], v[16:19], v[112:115], v[120:135]
    v_exp_f32 v159, v159
    v_exp_f32 v160, v160
    v_exp_f32 v161, v161
    v_exp_f32 v162, v162
    v_smfmac_f32_32x32x32_bf16 v[184:199], v[104:107], v[152:159], v9
    v_exp_f32 v163, v163
    v_exp_f32 v164, v164
    v_exp_f32 v165, v165
    v_exp_f32 v166, v166
    v_exp_f32 v167, v167
    s_nop 1
    v_exp_f32 v136, v136
    v_exp_f32 v137, v137
    v_smfmac_f32_32x32x32_bf16 v[184:199], v[108:111], v[160:167], v9
    v_exp_f32 v138, v138
    v_exp_f32 v139, v139
    v_exp_f32 v140, v140
    v_mfma_f32_32x32x16_bf16 v[152:167], v[20:23], v[112:115], v[120:135]
    v_exp_f32 v141, v141
    v_exp_f32 v142, v142
    v_exp_f32 v143, v143
    v_exp_f32 v144, v144
    v_exp_f32 v145, v145
    v_smfmac_f32_32x32x32_bf16 v[168:183], v[48:51], v[136:143], v9
    s_setprio 1
    v_exp_f32 v146, v146
    v_exp_f32 v147, v147
    v_exp_f32 v148, v148
    v_exp_f32 v149, v149
    ds_write_b64 v14, v[184:185] offset:17408
    v_exp_f32 v150, v150
    v_exp_f32 v151, v151
    v_exp_f32 v152, v152
    v_exp_f32 v153, v153
    v_smfmac_f32_32x32x32_bf16 v[168:183], v[52:55], v[144:151], v9
    ds_write_b64 v14, v[186:187] offset:21504
    ds_write_b64 v14, v[188:189] offset:25600
    v_exp_f32 v154, v154
    v_exp_f32 v155, v155
    v_exp_f32 v156, v156
    v_mfma_f32_32x32x16_bf16 v[136:151], v[24:27], v[112:115], v[120:135]
    ds_write_b64 v14, v[190:191] offset:29696
    v_exp_f32 v157, v157
    v_exp_f32 v158, v158
    v_exp_f32 v159, v159
    v_exp_f32 v160, v160
    v_exp_f32 v161, v161
    v_smfmac_f32_32x32x32_bf16 v[168:183], v[56:59], v[152:159], v9
    ds_write_b32 v15, v192 offset:33792
    s_setprio 0
    v_exp_f32 v162, v162
    v_exp_f32 v163, v163
    v_exp_f32 v164, v164
    v_exp_f32 v165, v165
    v_exp_f32 v166, v166
    v_exp_f32 v167, v167
    v_exp_f32 v136, v136
    v_exp_f32 v137, v137
    v_smfmac_f32_32x32x32_bf16 v[168:183], v[60:63], v[160:167], v9
    v_exp_f32 v138, v138
    v_exp_f32 v139, v139
    v_exp_f32 v140, v140
    v_mfma_f32_32x32x16_bf16 v[152:167], v[28:31], v[112:115], v[120:135]
    v_exp_f32 v141, v141
    v_exp_f32 v142, v142
    v_exp_f32 v143, v143
    v_exp_f32 v144, v144
    v_exp_f32 v145, v145
    v_smfmac_f32_32x32x32_bf16 v[168:183], v[64:67], v[136:143], v9
    s_waitcnt lgkmcnt(0)
    s_barrier
    s_setprio 3
    v_exp_f32 v146, v146
    v_exp_f32 v147, v147
    v_exp_f32 v148, v148
    v_exp_f32 v149, v149
    v_exp_f32 v150, v150
    v_exp_f32 v151, v151
    v_exp_f32 v152, v152
    v_exp_f32 v153, v153
    v_smfmac_f32_32x32x32_bf16 v[168:183], v[68:71], v[144:151], v9
    v_exp_f32 v154, v154
    v_exp_f32 v155, v155
    v_exp_f32 v156, v156
    v_mfma_f32_32x32x16_bf16 v[136:151], v[32:35], v[112:115], v[120:135]
    v_exp_f32 v157, v157
    v_exp_f32 v158, v158
    v_exp_f32 v159, v159
    v_exp_f32 v160, v160
    v_exp_f32 v161, v161
    v_smfmac_f32_32x32x32_bf16 v[168:183], v[72:75], v[152:159], v9
    ds_read_b128 v[240:243], v7 offset:38912
    s_add_u32 m0, s42, 8192
    s_xor_b32 s46, s41, 53248
    v_exp_f32 v162, v162
    v_exp_f32 v163, v163
    v_exp_f32 v164, v164
    v_exp_f32 v165, v165
    v_exp_f32 v166, v166
    v_exp_f32 v167, v167
    v_exp_f32 v136, v136
    v_exp_f32 v137, v137
    v_smfmac_f32_32x32x32_bf16 v[168:183], v[76:79], v[160:167], v9
    s_waitcnt vmcnt(2)
    v_exp_f32 v138, v138
    v_exp_f32 v139, v139
    v_exp_f32 v140, v140
    v_mfma_f32_32x32x16_bf16 v[152:167], v[36:39], v[112:115], v[120:135]
    ds_read_b128 v[244:247], v7 offset:39424
    buffer_load_dwordx4 v3, s[28:31], s46 offen offset:0 sc1 lds
    v_exp_f32 v141, v141
    v_exp_f32 v142, v142
    v_exp_f32 v143, v143
    v_exp_f32 v144, v144
    v_exp_f32 v145, v145
    v_smfmac_f32_32x32x32_bf16 v[168:183], v[80:83], v[136:143], v9
    s_waitcnt lgkmcnt(0)
    v_exp_f32 v146, v146
    v_exp_f32 v147, v147
    v_exp_f32 v148, v148
    v_exp_f32 v149, v149
    v_mfma_f32_16x16x32_bf16 v[200:203], v[216:219], v[240:243], 0
    s_xor_b32 s43, s41, 4096
    buffer_load_dwordx4 v[216:219], v3, s[28:31], s43 offen offset:0 sc1
    v_exp_f32 v150, v150
    v_exp_f32 v151, v151
    v_exp_f32 v152, v152
    v_exp_f32 v153, v153
    v_smfmac_f32_32x32x32_bf16 v[168:183], v[84:87], v[144:151], v9
    v_exp_f32 v154, v154
    v_exp_f32 v155, v155
    v_exp_f32 v156, v156
    v_mfma_f32_32x32x16_bf16 v[136:151], v[40:43], v[112:115], v[120:135]
    buffer_load_dwordx4 v3, s[28:31], s46 offen offset:1024 sc1 lds
    v_exp_f32 v157, v157
    v_exp_f32 v158, v158
    v_exp_f32 v159, v159
    v_exp_f32 v160, v160
    v_exp_f32 v161, v161
    v_smfmac_f32_32x32x32_bf16 v[168:183], v[88:91], v[152:159], v9
    s_setprio 2
    v_exp_f32 v162, v162
    v_exp_f32 v163, v163
    v_exp_f32 v164, v164
    v_exp_f32 v165, v165
    v_mfma_f32_16x16x32_bf16 v[204:207], v[220:223], v[240:243], 0
    buffer_load_dwordx4 v[220:223], v3, s[28:31], s43 offen offset:1024 sc1
    v_exp_f32 v166, v166
    v_exp_f32 v167, v167
    v_exp_f32 v136, v136
    v_exp_f32 v137, v137
    v_smfmac_f32_32x32x32_bf16 v[168:183], v[92:95], v[160:167], v9
    s_waitcnt vmcnt(4)
    v_exp_f32 v138, v138
    v_exp_f32 v139, v139
    v_exp_f32 v140, v140
    v_mfma_f32_32x32x16_bf16 v[152:167], v[44:47], v[112:115], v[120:135]
    ds_read_b128 v[112:115], v3 offset:44032
    v_exp_f32 v141, v141
    v_exp_f32 v142, v142
    v_exp_f32 v143, v143
    v_exp_f32 v144, v144
    v_exp_f32 v145, v145
    v_smfmac_f32_32x32x32_bf16 v[168:183], v[96:99], v[136:143], v9
    ds_read_b128 v[120:123], v0 offset:36352
    ds_read_b128 v[124:127], v0 offset:36352
    ds_read_b128 v[128:131], v0 offset:36352
    ds_read_b128 v[132:135], v0 offset:36352
    v_exp_f32 v146, v146
    v_exp_f32 v147, v147
    v_exp_f32 v148, v148
    v_exp_f32 v149, v149
    v_mfma_f32_16x16x32_bf16 v[208:211], v[224:227], v[240:243], 0
    buffer_load_dwordx4 v[224:227], v3, s[28:31], s43 offen offset:2048 sc1
    v_exp_f32 v150, v150
    v_exp_f32 v151, v151
    v_mfma_f32_32x32x16_bf16 v[184:199], v[116:119], v[116:119], 0
    v_exp_f32 v152, v152
    v_exp_f32 v153, v153
    v_smfmac_f32_32x32x32_bf16 v[168:183], v[100:103], v[144:151], v9
    v_exp_f32 v154, v154
    v_exp_f32 v155, v155
    v_exp_f32 v156, v156
    v_exp_f32 v157, v157
    v_exp_f32 v158, v158
    s_waitcnt lgkmcnt(0)
    v_mfma_f32_32x32x16_bf16 v[136:151], v[16:19], v[112:115], v[120:135]
    buffer_load_dwordx4 v3, s[28:31], s46 offen offset:2048 sc1 lds
    v_exp_f32 v159, v159
    v_exp_f32 v160, v160
    v_exp_f32 v161, v161
    v_exp_f32 v162, v162
    v_smfmac_f32_32x32x32_bf16 v[168:183], v[104:107], v[152:159], v9
    v_exp_f32 v163, v163
    v_exp_f32 v164, v164
    v_exp_f32 v165, v165
    v_mfma_f32_16x16x32_bf16 v[212:215], v[228:231], v[240:243], 0
    buffer_load_dwordx4 v[228:231], v3, s[28:31], s43 offen offset:3072 sc1
    v_exp_f32 v166, v166
    v_exp_f32 v167, v167
    v_exp_f32 v136, v136
    v_exp_f32 v137, v137
    v_smfmac_f32_32x32x32_bf16 v[168:183], v[108:111], v[160:167], v9
    s_waitcnt vmcnt(3)
    v_exp_f32 v138, v138
    v_exp_f32 v139, v139
    v_exp_f32 v140, v140
    v_mfma_f32_32x32x16_bf16 v[152:167], v[20:23], v[112:115], v[120:135]
    buffer_load_dwordx4 v3, s[28:31], s46 offen offset:3072 sc1 lds
    v_exp_f32 v141, v141
    v_exp_f32 v142, v142
    v_exp_f32 v143, v143
    v_exp_f32 v144, v144
    v_exp_f32 v145, v145
    v_smfmac_f32_32x32x32_bf16 v[184:199], v[48:51], v[136:143], v9
    s_setprio 1
    s_add_u32 m0, s42, 12288
    s_xor_b32 s46, s41, 57344
    v_exp_f32 v146, v146
    v_exp_f32 v147, v147
    v_exp_f32 v148, v148
    v_exp_f32 v149, v149
    v_mfma_f32_16x16x32_bf16 v[200:203], v[216:219], v[244:247], v[200:203]
    ds_write_b64 v14, v[168:169] offset:0
    s_xor_b32 s43, s41, 8192
    buffer_load_dwordx4 v[216:219], v3, s[28:31], s43 offen offset:0 sc1
    v_exp_f32 v150, v150
    v_exp_f32 v151, v151
    v_exp_f32 v152, v152
    v_exp_f32 v153, v153
    v_smfmac_f32_32x32x32_bf16 v[184:199], v[52:55], v[144:151], v9
    ds_write_b64 v14, v[170:171] offset:4096
    ds_write_b64 v14, v[172:173] offset:8192
    v_exp_f32 v154, v154
    v_exp_f32 v155, v155
    v_exp_f32 v156, v156
    v_mfma_f32_32x32x16_bf16 v[136:151], v[24:27], v[112:115], v[120:135]
    ds_write_b64 v14, v[174:175] offset:12288
    buffer_load_dwordx4 v3, s[28:31], s46 offen offset:0 sc1 lds
    v_exp_f32 v157, v157
    v_exp_f32 v158, v158
    v_exp_f32 v159, v159
    v_exp_f32 v160, v160
    v_exp_f32 v161, v161
    v_smfmac_f32_32x32x32_bf16 v[184:199], v[56:59], v[152:159], v9
    ds_write_b32 v15, v176 offset:16384
    s_setprio 0
    v_exp_f32 v162, v162
    v_exp_f32 v163, v163
    v_exp_f32 v164, v164
    v_exp_f32 v165, v165
    v_mfma_f32_16x16x32_bf16 v[204:207], v[220:223], v[244:247], v[204:207]
    buffer_load_dwordx4 v[220:223], v3, s[28:31], s43 offen offset:1024 sc1
    v_exp_f32 v166, v166
    v_exp_f32 v167, v167
    v_exp_f32 v136, v136
    v_exp_f32 v137, v137
    v_smfmac_f32_32x32x32_bf16 v[184:199], v[60:63], v[160:167], v9
    s_waitcnt vmcnt(4)
    s_lshl_b32 s13, s52, 4
    s_mov_b32 s46, s53
    v_exp_f32 v138, v138
    v_exp_f32 v139, v139
    v_exp_f32 v140, v140
    v_mfma_f32_32x32x16_bf16 v[152:167], v[28:31], v[112:115], v[120:135]
    v_exp_f32 v141, v141
    v_exp_f32 v142, v142
    v_exp_f32 v143, v143
    v_exp_f32 v144, v144
    v_exp_f32 v145, v145
    v_smfmac_f32_32x32x32_bf16 v[184:199], v[64:67], v[136:143], v9
    s_waitcnt lgkmcnt(0)
    s_barrier
    s_setprio 3
    s_add_u32 m0, s42, 0
    v_exp_f32 v146, v146
    v_exp_f32 v147, v147
    v_exp_f32 v148, v148
    v_exp_f32 v149, v149
    v_mfma_f32_16x16x32_bf16 v[208:211], v[224:227], v[244:247], v[208:211]
    buffer_load_dwordx4 v[224:227], v3, s[28:31], s43 offen offset:2048 sc1
    v_exp_f32 v150, v150
    v_exp_f32 v151, v151
    v_exp_f32 v152, v152
    v_exp_f32 v153, v153
    v_smfmac_f32_32x32x32_bf16 v[184:199], v[68:71], v[144:151], v9
    v_exp_f32 v154, v154
    v_exp_f32 v155, v155
    v_exp_f32 v156, v156
    v_mfma_f32_32x32x16_bf16 v[136:151], v[32:35], v[112:115], v[120:135]
    v_exp_f32 v157, v157
    v_exp_f32 v158, v158
    v_exp_f32 v159, v159
    v_exp_f32 v160, v160
    v_exp_f32 v161, v161
    v_smfmac_f32_32x32x32_bf16 v[184:199], v[72:75], v[152:159], v9
    ds_read_b128 v[240:243], v7 offset:39936
    v_exp_f32 v162, v162
    v_exp_f32 v163, v163
    v_exp_f32 v164, v164
    v_exp_f32 v165, v165
    v_mfma_f32_16x16x32_bf16 v[212:215], v[228:231], v[244:247], v[212:215]
    buffer_load_dwordx4 v[228:231], v3, s[28:31], s43 offen offset:3072 sc1
    v_exp_f32 v166, v166
    v_exp_f32 v167, v167
    v_exp_f32 v136, v136
    v_exp_f32 v137, v137
    v_smfmac_f32_32x32x32_bf16 v[184:199], v[76:79], v[160:167], v9
    s_waitcnt vmcnt(2)
    v_exp_f32 v138, v138
    v_exp_f32 v139, v139
    v_exp_f32 v140, v140
    v_mfma_f32_32x32x16_bf16 v[152:167], v[36:39], v[112:115], v[120:135]
    ds_read_b128 v[244:247], v7 offset:40448
    v_exp_f32 v141, v141
    v_exp_f32 v142, v142
    v_exp_f32 v143, v143
    v_exp_f32 v144, v144
    v_exp_f32 v145, v145
    v_smfmac_f32_32x32x32_bf16 v[184:199], v[80:83], v[136:143], v9
    s_waitcnt lgkmcnt(0)
    v_exp_f32 v146, v146
    v_exp_f32 v147, v147
    v_exp_f32 v148, v148
    v_exp_f32 v149, v149
    v_mfma_f32_16x16x32_bf16 v[200:203], v[216:219], v[240:243], v[200:203]
    s_xor_b32 s43, s41, 12288
    buffer_load_dwordx4 v[216:219], v3, s[28:31], s43 offen offset:0 sc1
    v_exp_f32 v150, v150
    v_exp_f32 v151, v151
    v_exp_f32 v152, v152
    v_exp_f32 v153, v153
    v_smfmac_f32_32x32x32_bf16 v[184:199], v[84:87], v[144:151], v9
    v_exp_f32 v154, v154
    v_exp_f32 v155, v155
    v_exp_f32 v156, v156
    v_mfma_f32_32x32x16_bf16 v[136:151], v[40:43], v[112:115], v[120:135]
    buffer_load_dwordx4 v8, s[56:59], s46 offen lds
    v_exp_f32 v157, v157
    v_exp_f32 v158, v158
    v_exp_f32 v159, v159
    v_exp_f32 v160, v160
    v_exp_f32 v161, v161
    v_smfmac_f32_32x32x32_bf16 v[184:199], v[88:91], v[152:159], v9
    s_setprio 2
    v_exp_f32 v162, v162
    v_exp_f32 v163, v163
    v_exp_f32 v164, v164
    v_exp_f32 v165, v165
    v_mfma_f32_16x16x32_bf16 v[204:207], v[220:223], v[240:243], v[204:207]
    buffer_load_dwordx4 v[220:223], v3, s[28:31], s43 offen offset:1024 sc1
    v_exp_f32 v166, v166
    v_exp_f32 v167, v167
    v_exp_f32 v136, v136
    v_exp_f32 v137, v137
    v_smfmac_f32_32x32x32_bf16 v[184:199], v[92:95], v[160:167], v9
    s_waitcnt vmcnt(3)
    s_add_u32 m0, s42, 1024
    s_add_u32 s46, s46, s13
    v_exp_f32 v138, v138
    v_exp_f32 v139, v139
    v_exp_f32 v140, v140
    v_mfma_f32_32x32x16_bf16 v[152:167], v[44:47], v[112:115], v[120:135]
    ds_read_b128 v[112:115], v3 offset:45056
    v_exp_f32 v141, v141
    v_exp_f32 v142, v142
    v_exp_f32 v143, v143
    v_exp_f32 v144, v144
    v_exp_f32 v145, v145
    v_smfmac_f32_32x32x32_bf16 v[184:199], v[96:99], v[136:143], v9
    ds_read_b128 v[120:123], v0 offset:36864
    ds_read_b128 v[124:127], v0 offset:36864
    ds_read_b128 v[128:131], v0 offset:36864
    ds_read_b128 v[132:135], v0 offset:36864
    v_exp_f32 v146, v146
    v_exp_f32 v147, v147
    v_exp_f32 v148, v148
    v_exp_f32 v149, v149
    v_mfma_f32_16x16x32_bf16 v[208:211], v[224:227], v[240:243], v[208:211]
    buffer_load_dwordx4 v[224:227], v3, s[28:31], s43 offen offset:2048 sc1
    v_exp_f32 v150, v150
    v_exp_f32 v151, v151
    v_mfma_f32_32x32x16_bf16 v[168:183], v[116:119], v[116:119], 0
    v_exp_f32 v152, v152
    v_exp_f32 v153, v153
    v_smfmac_f32_32x32x32_bf16 v[184:199], v[100:103], v[144:151], v9
    v_exp_f32 v154, v154
    v_exp_f32 v155, v155
    v_exp_f32 v156, v156
    v_exp_f32 v157, v157
    v_exp_f32 v158, v158
    s_waitcnt lgkmcnt(0)
    v_mfma_f32_32x32x16_bf16 v[136:151], v[16:19], v[112:115], v[120:135]
    buffer_load_dwordx4 v8, s[56:59], s46 offen lds
    v_exp_f32 v159, v159
    v_exp_f32 v160, v160
    v_exp_f32 v161, v161
    v_exp_f32 v162, v162
    v_smfmac_f32_32x32x32_bf16 v[184:199], v[104:107], v[152:159], v9
    s_add_u32 m0, s42, 2048
    s_add_u32 s46, s46, s13
    v_exp_f32 v163, v163
    v_exp_f32 v164, v164
    v_exp_f32 v165, v165
    v_mfma_f32_16x16x32_bf16 v[212:215], v[228:231], v[240:243], v[212:215]
    buffer_load_dwordx4 v[228:231], v3, s[28:31], s43 offen offset:3072 sc1
    v_exp_f32 v166, v166
    v_exp_f32 v167, v167
    v_exp_f32 v136, v136
    v_exp_f32 v137, v137
    v_smfmac_f32_32x32x32_bf16 v[184:199], v[108:111], v[160:167], v9
    s_waitcnt vmcnt(3)
    v_exp_f32 v138, v138
    v_exp_f32 v139, v139
    v_exp_f32 v140, v140
    v_mfma_f32_32x32x16_bf16 v[152:167], v[20:23], v[112:115], v[120:135]
    buffer_load_dwordx4 v8, s[56:59], s46 offen lds
    v_exp_f32 v141, v141
    v_exp_f32 v142, v142
    v_exp_f32 v143, v143
    v_exp_f32 v144, v144
    v_exp_f32 v145, v145
    v_smfmac_f32_32x32x32_bf16 v[168:183], v[48:51], v[136:143], v9
    s_setprio 1
    v_exp_f32 v146, v146
    v_exp_f32 v147, v147
    v_exp_f32 v148, v148
    v_exp_f32 v149, v149
    v_mfma_f32_16x16x32_bf16 v[200:203], v[216:219], v[244:247], v[200:203]
    ds_write_b64 v14, v[184:185] offset:17408
    s_xor_b32 s43, s41, 16384
    buffer_load_dwordx4 v[216:219], v3, s[28:31], s43 offen offset:0 sc1
    v_exp_f32 v150, v150
    v_exp_f32 v151, v151
    v_exp_f32 v152, v152
    v_exp_f32 v153, v153
    v_smfmac_f32_32x32x32_bf16 v[168:183], v[52:55], v[144:151], v9
    ds_write_b64 v14, v[186:187] offset:21504
    ds_write_b64 v14, v[188:189] offset:25600
    v_exp_f32 v154, v154
    v_exp_f32 v155, v155
    v_exp_f32 v156, v156
    v_mfma_f32_32x32x16_bf16 v[136:151], v[24:27], v[112:115], v[120:135]
    ds_write_b64 v14, v[190:191] offset:29696
    v_exp_f32 v157, v157
    v_exp_f32 v158, v158
    v_exp_f32 v159, v159
    v_exp_f32 v160, v160
    v_exp_f32 v161, v161
    v_smfmac_f32_32x32x32_bf16 v[168:183], v[56:59], v[152:159], v9
    ds_write_b32 v15, v192 offset:33792
    s_setprio 0
    v_exp_f32 v162, v162
    v_exp_f32 v163, v163
    v_exp_f32 v164, v164
    v_exp_f32 v165, v165
    v_mfma_f32_16x16x32_bf16 v[204:207], v[220:223], v[244:247], v[204:207]
    buffer_load_dwordx4 v[220:223], v3, s[28:31], s43 offen offset:1024 sc1
    v_exp_f32 v166, v166
    v_exp_f32 v167, v167
    v_exp_f32 v136, v136
    v_exp_f32 v137, v137
    v_smfmac_f32_32x32x32_bf16 v[168:183], v[60:63], v[160:167], v9
    s_waitcnt vmcnt(3)
    v_exp_f32 v138, v138
    v_exp_f32 v139, v139
    v_exp_f32 v140, v140
    v_mfma_f32_32x32x16_bf16 v[152:167], v[28:31], v[112:115], v[120:135]
    v_exp_f32 v141, v141
    v_exp_f32 v142, v142
    v_exp_f32 v143, v143
    v_exp_f32 v144, v144
    v_exp_f32 v145, v145
    v_smfmac_f32_32x32x32_bf16 v[168:183], v[64:67], v[136:143], v9
    s_waitcnt lgkmcnt(0)
    s_barrier
    s_setprio 3
    s_add_u32 m0, s42, 3072
    s_add_u32 s46, s46, s13
    v_exp_f32 v146, v146
    v_exp_f32 v147, v147
    v_exp_f32 v148, v148
    v_exp_f32 v149, v149
    v_mfma_f32_16x16x32_bf16 v[208:211], v[224:227], v[244:247], v[208:211]
    buffer_load_dwordx4 v[224:227], v3, s[28:31], s43 offen offset:2048 sc1
    v_exp_f32 v150, v150
    v_exp_f32 v151, v151
    v_exp_f32 v152, v152
    v_exp_f32 v153, v153
    v_smfmac_f32_32x32x32_bf16 v[168:183], v[68:71], v[144:151], v9
    v_exp_f32 v154, v154
    v_exp_f32 v155, v155
    v_exp_f32 v156, v156
    v_mfma_f32_32x32x16_bf16 v[136:151], v[32:35], v[112:115], v[120:135]
    v_exp_f32 v157, v157
    v_exp_f32 v158, v158
    v_exp_f32 v159, v159
    v_exp_f32 v160, v160
    v_exp_f32 v161, v161
    v_smfmac_f32_32x32x32_bf16 v[168:183], v[72:75], v[152:159], v9
    ds_read_b128 v[240:243], v7 offset:38912
    v_exp_f32 v162, v162
    v_exp_f32 v163, v163
    v_exp_f32 v164, v164
    v_exp_f32 v165, v165
    v_mfma_f32_16x16x32_bf16 v[212:215], v[228:231], v[244:247], v[212:215]
    buffer_load_dwordx4 v[228:231], v3, s[28:31], s43 offen offset:3072 sc1
    v_exp_f32 v166, v166
    v_exp_f32 v167, v167
    v_exp_f32 v136, v136
    v_exp_f32 v137, v137
    v_smfmac_f32_32x32x32_bf16 v[168:183], v[76:79], v[160:167], v9
    s_waitcnt vmcnt(2)
    v_exp_f32 v138, v138
    v_exp_f32 v139, v139
    v_exp_f32 v140, v140
    v_mfma_f32_32x32x16_bf16 v[152:167], v[36:39], v[112:115], v[120:135]
    ds_read_b128 v[244:247], v7 offset:39424
    v_exp_f32 v141, v141
    v_exp_f32 v142, v142
    v_exp_f32 v143, v143
    v_exp_f32 v144, v144
    v_exp_f32 v145, v145
    v_smfmac_f32_32x32x32_bf16 v[168:183], v[80:83], v[136:143], v9
    s_waitcnt lgkmcnt(0)
    v_exp_f32 v146, v146
    v_exp_f32 v147, v147
    v_exp_f32 v148, v148
    v_exp_f32 v149, v149
    v_mfma_f32_16x16x32_bf16 v[200:203], v[216:219], v[240:243], v[200:203]
    s_xor_b32 s43, s41, 20480
    buffer_load_dwordx4 v[216:219], v3, s[28:31], s43 offen offset:0 sc1
    v_exp_f32 v150, v150
    v_exp_f32 v151, v151
    v_exp_f32 v152, v152
    v_exp_f32 v153, v153
    v_smfmac_f32_32x32x32_bf16 v[168:183], v[84:87], v[144:151], v9
    v_exp_f32 v154, v154
    v_exp_f32 v155, v155
    v_exp_f32 v156, v156
    v_mfma_f32_32x32x16_bf16 v[136:151], v[40:43], v[112:115], v[120:135]
    buffer_load_dwordx4 v8, s[56:59], s46 offen lds
    v_exp_f32 v157, v157
    v_exp_f32 v158, v158
    v_exp_f32 v159, v159
    v_exp_f32 v160, v160
    v_exp_f32 v161, v161
    v_smfmac_f32_32x32x32_bf16 v[168:183], v[88:91], v[152:159], v9
    s_setprio 2
    v_exp_f32 v162, v162
    v_exp_f32 v163, v163
    v_exp_f32 v164, v164
    v_exp_f32 v165, v165
    v_mfma_f32_16x16x32_bf16 v[204:207], v[220:223], v[240:243], v[204:207]
    buffer_load_dwordx4 v[220:223], v3, s[28:31], s43 offen offset:1024 sc1
    v_exp_f32 v166, v166
    v_exp_f32 v167, v167
    v_exp_f32 v136, v136
    v_exp_f32 v137, v137
    v_smfmac_f32_32x32x32_bf16 v[168:183], v[92:95], v[160:167], v9
    s_waitcnt vmcnt(3)
    s_add_u32 m0, s42, 4096
    s_add_u32 s46, s46, s13
    v_exp_f32 v138, v138
    v_exp_f32 v139, v139
    v_exp_f32 v140, v140
    v_mfma_f32_32x32x16_bf16 v[152:167], v[44:47], v[112:115], v[120:135]
    ds_read_b128 v[112:115], v3 offset:46080
    v_exp_f32 v141, v141
    v_exp_f32 v142, v142
    v_exp_f32 v143, v143
    v_exp_f32 v144, v144
    v_exp_f32 v145, v145
    v_smfmac_f32_32x32x32_bf16 v[168:183], v[96:99], v[136:143], v9
    ds_read_b128 v[120:123], v0 offset:37376
    ds_read_b128 v[124:127], v0 offset:37376
    ds_read_b128 v[128:131], v0 offset:37376
    ds_read_b128 v[132:135], v0 offset:37376
    v_exp_f32 v146, v146
    v_exp_f32 v147, v147
    v_exp_f32 v148, v148
    v_exp_f32 v149, v149
    v_mfma_f32_16x16x32_bf16 v[208:211], v[224:227], v[240:243], v[208:211]
    buffer_load_dwordx4 v[224:227], v3, s[28:31], s43 offen offset:2048 sc1
    v_exp_f32 v150, v150
    v_exp_f32 v151, v151
    v_mfma_f32_32x32x16_bf16 v[184:199], v[116:119], v[116:119], 0
    v_exp_f32 v152, v152
    v_exp_f32 v153, v153
    v_smfmac_f32_32x32x32_bf16 v[168:183], v[100:103], v[144:151], v9
    v_exp_f32 v154, v154
    v_exp_f32 v155, v155
    v_exp_f32 v156, v156
    v_exp_f32 v157, v157
    v_exp_f32 v158, v158
    s_waitcnt lgkmcnt(0)
    v_mfma_f32_32x32x16_bf16 v[136:151], v[16:19], v[112:115], v[120:135]
    buffer_load_dwordx4 v8, s[56:59], s46 offen lds
    v_exp_f32 v159, v159
    v_exp_f32 v160, v160
    v_exp_f32 v161, v161
    v_exp_f32 v162, v162
    v_smfmac_f32_32x32x32_bf16 v[168:183], v[104:107], v[152:159], v9
    s_add_u32 m0, s42, 5120
    s_add_u32 s46, s46, s13
    v_exp_f32 v163, v163
    v_exp_f32 v164, v164
    v_exp_f32 v165, v165
    v_mfma_f32_16x16x32_bf16 v[212:215], v[228:231], v[240:243], v[212:215]
    buffer_load_dwordx4 v[228:231], v3, s[28:31], s43 offen offset:3072 sc1
    v_exp_f32 v166, v166
    v_exp_f32 v167, v167
    v_exp_f32 v136, v136
    v_exp_f32 v137, v137
    v_smfmac_f32_32x32x32_bf16 v[168:183], v[108:111], v[160:167], v9
    s_waitcnt vmcnt(3)
    v_exp_f32 v138, v138
    v_exp_f32 v139, v139
    v_exp_f32 v140, v140
    v_mfma_f32_32x32x16_bf16 v[152:167], v[20:23], v[112:115], v[120:135]
    buffer_load_dwordx4 v8, s[56:59], s46 offen lds
    v_exp_f32 v141, v141
    v_exp_f32 v142, v142
    v_exp_f32 v143, v143
    v_exp_f32 v144, v144
    v_exp_f32 v145, v145
    v_smfmac_f32_32x32x32_bf16 v[184:199], v[48:51], v[136:143], v9
    s_setprio 1
    v_exp_f32 v146, v146
    v_exp_f32 v147, v147
    v_exp_f32 v148, v148
    v_exp_f32 v149, v149
    v_mfma_f32_16x16x32_bf16 v[200:203], v[216:219], v[244:247], v[200:203]
    ds_write_b64 v14, v[168:169] offset:0
    s_xor_b32 s43, s41, 24576
    buffer_load_dwordx4 v[216:219], v3, s[28:31], s43 offen offset:0 sc1
    v_exp_f32 v150, v150
    v_exp_f32 v151, v151
    v_exp_f32 v152, v152
    v_exp_f32 v153, v153
    v_smfmac_f32_32x32x32_bf16 v[184:199], v[52:55], v[144:151], v9
    ds_write_b64 v14, v[170:171] offset:4096
    ds_write_b64 v14, v[172:173] offset:8192
    v_exp_f32 v154, v154
    v_exp_f32 v155, v155
    v_exp_f32 v156, v156
    v_mfma_f32_32x32x16_bf16 v[136:151], v[24:27], v[112:115], v[120:135]
    ds_write_b64 v14, v[174:175] offset:12288
    v_exp_f32 v157, v157
    v_exp_f32 v158, v158
    v_exp_f32 v159, v159
    v_exp_f32 v160, v160
    v_exp_f32 v161, v161
    v_smfmac_f32_32x32x32_bf16 v[184:199], v[56:59], v[152:159], v9
    ds_write_b32 v15, v176 offset:16384
    s_setprio 0
    v_exp_f32 v162, v162
    v_exp_f32 v163, v163
    v_exp_f32 v164, v164
    v_exp_f32 v165, v165
    v_mfma_f32_16x16x32_bf16 v[204:207], v[220:223], v[244:247], v[204:207]
    buffer_load_dwordx4 v[220:223], v3, s[28:31], s43 offen offset:1024 sc1
    v_exp_f32 v166, v166
    v_exp_f32 v167, v167
    v_exp_f32 v136, v136
    v_exp_f32 v137, v137
    v_smfmac_f32_32x32x32_bf16 v[184:199], v[60:63], v[160:167], v9
    s_waitcnt vmcnt(3)
    v_exp_f32 v138, v138
    v_exp_f32 v139, v139
    v_exp_f32 v140, v140
    v_mfma_f32_32x32x16_bf16 v[152:167], v[28:31], v[112:115], v[120:135]
    v_exp_f32 v141, v141
    v_exp_f32 v142, v142
    v_exp_f32 v143, v143
    v_exp_f32 v144, v144
    v_exp_f32 v145, v145
    v_smfmac_f32_32x32x32_bf16 v[184:199], v[64:67], v[136:143], v9
    s_waitcnt lgkmcnt(0)
    s_barrier
    s_setprio 3
    s_add_u32 m0, s42, 6144
    s_add_u32 s46, s46, s13
    v_exp_f32 v146, v146
    v_exp_f32 v147, v147
    v_exp_f32 v148, v148
    v_exp_f32 v149, v149
    v_mfma_f32_16x16x32_bf16 v[208:211], v[224:227], v[244:247], v[208:211]
    buffer_load_dwordx4 v[224:227], v3, s[28:31], s43 offen offset:2048 sc1
    v_exp_f32 v150, v150
    v_exp_f32 v151, v151
    v_exp_f32 v152, v152
    v_exp_f32 v153, v153
    v_smfmac_f32_32x32x32_bf16 v[184:199], v[68:71], v[144:151], v9
    v_exp_f32 v154, v154
    v_exp_f32 v155, v155
    v_exp_f32 v156, v156
    v_mfma_f32_32x32x16_bf16 v[136:151], v[32:35], v[112:115], v[120:135]
    v_exp_f32 v157, v157
    v_exp_f32 v158, v158
    v_exp_f32 v159, v159
    v_exp_f32 v160, v160
    v_exp_f32 v161, v161
    v_smfmac_f32_32x32x32_bf16 v[184:199], v[72:75], v[152:159], v9
    ds_read_b128 v[240:243], v7 offset:39936
    v_exp_f32 v162, v162
    v_exp_f32 v163, v163
    v_exp_f32 v164, v164
    v_exp_f32 v165, v165
    v_mfma_f32_16x16x32_bf16 v[212:215], v[228:231], v[244:247], v[212:215]
    buffer_load_dwordx4 v[228:231], v3, s[28:31], s43 offen offset:3072 sc1
    v_exp_f32 v166, v166
    v_exp_f32 v167, v167
    v_exp_f32 v136, v136
    v_exp_f32 v137, v137
    v_smfmac_f32_32x32x32_bf16 v[184:199], v[76:79], v[160:167], v9
    s_waitcnt vmcnt(2)
    v_exp_f32 v138, v138
    v_exp_f32 v139, v139
    v_exp_f32 v140, v140
    v_mfma_f32_32x32x16_bf16 v[152:167], v[36:39], v[112:115], v[120:135]
    ds_read_b128 v[244:247], v7 offset:40448
    v_exp_f32 v141, v141
    v_exp_f32 v142, v142
    v_exp_f32 v143, v143
    v_exp_f32 v144, v144
    v_exp_f32 v145, v145
    v_smfmac_f32_32x32x32_bf16 v[184:199], v[80:83], v[136:143], v9
    s_waitcnt lgkmcnt(0)
    v_exp_f32 v146, v146
    v_exp_f32 v147, v147
    v_exp_f32 v148, v148
    v_exp_f32 v149, v149
    v_mfma_f32_16x16x32_bf16 v[200:203], v[216:219], v[240:243], v[200:203]
    s_xor_b32 s43, s41, 28672
    buffer_load_dwordx4 v[216:219], v3, s[28:31], s43 offen offset:0 sc1
    v_exp_f32 v150, v150
    v_exp_f32 v151, v151
    v_exp_f32 v152, v152
    v_exp_f32 v153, v153
    v_smfmac_f32_32x32x32_bf16 v[184:199], v[84:87], v[144:151], v9
    v_exp_f32 v154, v154
    v_exp_f32 v155, v155
    v_exp_f32 v156, v156
    v_mfma_f32_32x32x16_bf16 v[136:151], v[40:43], v[112:115], v[120:135]
    buffer_load_dwordx4 v8, s[56:59], s46 offen lds
    v_exp_f32 v157, v157
    v_exp_f32 v158, v158
    v_exp_f32 v159, v159
    v_exp_f32 v160, v160
    v_exp_f32 v161, v161
    v_smfmac_f32_32x32x32_bf16 v[184:199], v[88:91], v[152:159], v9
    s_setprio 2
    v_exp_f32 v162, v162
    v_exp_f32 v163, v163
    v_exp_f32 v164, v164
    v_exp_f32 v165, v165
    v_mfma_f32_16x16x32_bf16 v[204:207], v[220:223], v[240:243], v[204:207]
    buffer_load_dwordx4 v[220:223], v3, s[28:31], s43 offen offset:1024 sc1
    v_exp_f32 v166, v166
    v_exp_f32 v167, v167
    v_exp_f32 v136, v136
    v_exp_f32 v137, v137
    v_smfmac_f32_32x32x32_bf16 v[184:199], v[92:95], v[160:167], v9
    s_waitcnt vmcnt(3)
    s_add_u32 m0, s42, 7168
    s_add_u32 s46, s46, s13
    v_exp_f32 v138, v138
    v_exp_f32 v139, v139
    v_exp_f32 v140, v140
    v_mfma_f32_32x32x16_bf16 v[152:167], v[44:47], v[112:115], v[120:135]
    ds_read_b128 v[112:115], v3 offset:47104
    v_exp_f32 v141, v141
    v_exp_f32 v142, v142
    v_exp_f32 v143, v143
    v_exp_f32 v144, v144
    v_exp_f32 v145, v145
    v_smfmac_f32_32x32x32_bf16 v[184:199], v[96:99], v[136:143], v9
    ds_read_b128 v[120:123], v0 offset:37888
    ds_read_b128 v[124:127], v0 offset:37888
    ds_read_b128 v[128:131], v0 offset:37888
    ds_read_b128 v[132:135], v0 offset:37888
    v_exp_f32 v146, v146
    v_exp_f32 v147, v147
    v_exp_f32 v148, v148
    v_exp_f32 v149, v149
    v_mfma_f32_16x16x32_bf16 v[208:211], v[224:227], v[240:243], v[208:211]
    buffer_load_dwordx4 v[224:227], v3, s[28:31], s43 offen offset:2048 sc1
    v_exp_f32 v150, v150
    v_exp_f32 v151, v151
    v_mfma_f32_32x32x16_bf16 v[168:183], v[116:119], v[116:119], 0
    v_exp_f32 v152, v152
    v_exp_f32 v153, v153
    v_smfmac_f32_32x32x32_bf16 v[184:199], v[100:103], v[144:151], v9
    v_exp_f32 v154, v154
    v_exp_f32 v155, v155
    v_exp_f32 v156, v156
    v_exp_f32 v157, v157
    v_exp_f32 v158, v158
    s_waitcnt lgkmcnt(0)
    v_mfma_f32_32x32x16_bf16 v[136:151], v[16:19], v[112:115], v[120:135]
    buffer_load_dwordx4 v8, s[56:59], s46 offen lds
    v_exp_f32 v159, v159
    v_exp_f32 v160, v160
    v_exp_f32 v161, v161
    v_exp_f32 v162, v162
    v_smfmac_f32_32x32x32_bf16 v[184:199], v[104:107], v[152:159], v9
    v_exp_f32 v163, v163
    v_exp_f32 v164, v164
    v_exp_f32 v165, v165
    v_mfma_f32_16x16x32_bf16 v[212:215], v[228:231], v[240:243], v[212:215]
    buffer_load_dwordx4 v[228:231], v3, s[28:31], s43 offen offset:3072 sc1
    v_exp_f32 v166, v166
    v_exp_f32 v167, v167
    v_exp_f32 v136, v136
    v_exp_f32 v137, v137
    v_smfmac_f32_32x32x32_bf16 v[184:199], v[108:111], v[160:167], v9
    s_waitcnt vmcnt(3)
    v_exp_f32 v138, v138
    v_exp_f32 v139, v139
    v_exp_f32 v140, v140
    v_mfma_f32_32x32x16_bf16 v[152:167], v[20:23], v[112:115], v[120:135]
    v_exp_f32 v141, v141
    v_exp_f32 v142, v142
    v_exp_f32 v143, v143
    v_exp_f32 v144, v144
    v_exp_f32 v145, v145
    v_smfmac_f32_32x32x32_bf16 v[168:183], v[48:51], v[136:143], v9
    s_setprio 1
    v_exp_f32 v146, v146
    v_exp_f32 v147, v147
    v_exp_f32 v148, v148
    v_exp_f32 v149, v149
    v_mfma_f32_16x16x32_bf16 v[200:203], v[216:219], v[244:247], v[200:203]
    ds_write_b64 v14, v[184:185] offset:17408
    s_xor_b32 s43, s41, 32768
    buffer_load_dwordx4 v[216:219], v3, s[28:31], s43 offen offset:0 sc1
    v_exp_f32 v150, v150
    v_exp_f32 v151, v151
    v_exp_f32 v152, v152
    v_exp_f32 v153, v153
    v_smfmac_f32_32x32x32_bf16 v[168:183], v[52:55], v[144:151], v9
    ds_write_b64 v14, v[186:187] offset:21504
    ds_write_b64 v14, v[188:189] offset:25600
    v_exp_f32 v154, v154
    v_exp_f32 v155, v155
    v_exp_f32 v156, v156
    v_mfma_f32_32x32x16_bf16 v[136:151], v[24:27], v[112:115], v[120:135]
    ds_write_b64 v14, v[190:191] offset:29696
    v_exp_f32 v157, v157
    v_exp_f32 v158, v158
    v_exp_f32 v159, v159
    v_exp_f32 v160, v160
    v_exp_f32 v161, v161
    v_smfmac_f32_32x32x32_bf16 v[168:183], v[56:59], v[152:159], v9
    ds_write_b32 v15, v192 offset:33792
    s_setprio 0
    v_exp_f32 v162, v162
    v_exp_f32 v163, v163
    v_exp_f32 v164, v164
    v_exp_f32 v165, v165
    v_mfma_f32_16x16x32_bf16 v[204:207], v[220:223], v[244:247], v[204:207]
    buffer_load_dwordx4 v[220:223], v3, s[28:31], s43 offen offset:1024 sc1
    v_exp_f32 v166, v166
    v_exp_f32 v167, v167
    v_exp_f32 v136, v136
    v_exp_f32 v137, v137
    v_smfmac_f32_32x32x32_bf16 v[168:183], v[60:63], v[160:167], v9
    s_waitcnt vmcnt(2)
    v_exp_f32 v138, v138
    v_exp_f32 v139, v139
    v_exp_f32 v140, v140
    v_mfma_f32_32x32x16_bf16 v[152:167], v[28:31], v[112:115], v[120:135]
    v_exp_f32 v141, v141
    v_exp_f32 v142, v142
    v_exp_f32 v143, v143
    v_exp_f32 v144, v144
    v_exp_f32 v145, v145
    v_smfmac_f32_32x32x32_bf16 v[168:183], v[64:67], v[136:143], v9
    s_waitcnt lgkmcnt(0)
    s_barrier
    s_setprio 3
    v_exp_f32 v146, v146
    v_exp_f32 v147, v147
    v_exp_f32 v148, v148
    v_exp_f32 v149, v149
    v_mfma_f32_16x16x32_bf16 v[208:211], v[224:227], v[244:247], v[208:211]
    buffer_load_dwordx4 v[224:227], v3, s[28:31], s43 offen offset:2048 sc1
    v_exp_f32 v150, v150
    v_exp_f32 v151, v151
    v_exp_f32 v152, v152
    v_exp_f32 v153, v153
    v_smfmac_f32_32x32x32_bf16 v[168:183], v[68:71], v[144:151], v9
    v_exp_f32 v154, v154
    v_exp_f32 v155, v155
    v_exp_f32 v156, v156
    v_mfma_f32_32x32x16_bf16 v[136:151], v[32:35], v[112:115], v[120:135]
    v_exp_f32 v157, v157
    v_exp_f32 v158, v158
    v_exp_f32 v159, v159
    v_exp_f32 v160, v160
    v_exp_f32 v161, v161
    v_smfmac_f32_32x32x32_bf16 v[168:183], v[72:75], v[152:159], v9
    ds_read_b128 v[240:243], v7 offset:38912
    v_exp_f32 v162, v162
    v_exp_f32 v163, v163
    v_exp_f32 v164, v164
    v_exp_f32 v165, v165
    v_mfma_f32_16x16x32_bf16 v[212:215], v[228:231], v[244:247], v[212:215]
    buffer_load_dwordx4 v[228:231], v3, s[28:31], s43 offen offset:3072 sc1
    v_exp_f32 v166, v166
    v_exp_f32 v167, v167
    v_exp_f32 v136, v136
    v_exp_f32 v137, v137
    v_smfmac_f32_32x32x32_bf16 v[168:183], v[76:79], v[160:167], v9
    s_waitcnt vmcnt(2)
    v_exp_f32 v138, v138
    v_exp_f32 v139, v139
    v_exp_f32 v140, v140
    v_mfma_f32_32x32x16_bf16 v[152:167], v[36:39], v[112:115], v[120:135]
    ds_read_b128 v[244:247], v7 offset:39424
    v_exp_f32 v141, v141
    v_exp_f32 v142, v142
    v_exp_f32 v143, v143
    v_exp_f32 v144, v144
    v_exp_f32 v145, v145
    v_smfmac_f32_32x32x32_bf16 v[168:183], v[80:83], v[136:143], v9
    s_waitcnt lgkmcnt(0)
    buffer_load_dwordx4 v[252:255], v250, s[20:23], s10 offen
    v_exp_f32 v146, v146
    v_exp_f32 v147, v147
    v_exp_f32 v148, v148
    v_exp_f32 v149, v149
    v_mfma_f32_16x16x32_bf16 v[200:203], v[216:219], v[240:243], v[200:203]
    s_xor_b32 s43, s41, 36864
    buffer_load_dwordx4 v[216:219], v3, s[28:31], s43 offen offset:0 sc1
    v_exp_f32 v150, v150
    v_exp_f32 v151, v151
    v_exp_f32 v152, v152
    v_exp_f32 v153, v153
    v_smfmac_f32_32x32x32_bf16 v[168:183], v[84:87], v[144:151], v9
    v_exp_f32 v154, v154
    v_exp_f32 v155, v155
    v_exp_f32 v156, v156
    v_mfma_f32_32x32x16_bf16 v[136:151], v[40:43], v[112:115], v[120:135]
    v_exp_f32 v157, v157
    v_exp_f32 v158, v158
    v_exp_f32 v159, v159
    v_exp_f32 v160, v160
    v_exp_f32 v161, v161
    v_smfmac_f32_32x32x32_bf16 v[168:183], v[88:91], v[152:159], v9
    s_setprio 2
    buffer_load_dwordx4 v[248:251], v251, s[16:19], s40 offen
    v_exp_f32 v162, v162
    v_exp_f32 v163, v163
    v_exp_f32 v164, v164
    v_exp_f32 v165, v165
    v_mfma_f32_16x16x32_bf16 v[204:207], v[220:223], v[240:243], v[204:207]
    buffer_load_dwordx4 v[220:223], v3, s[28:31], s43 offen offset:1024 sc1
    v_exp_f32 v166, v166
    v_exp_f32 v167, v167
    v_exp_f32 v136, v136
    v_exp_f32 v137, v137
    v_smfmac_f32_32x32x32_bf16 v[168:183], v[92:95], v[160:167], v9
    s_waitcnt vmcnt(4)
    v_exp_f32 v138, v138
    v_exp_f32 v139, v139
    v_exp_f32 v140, v140
    v_mfma_f32_32x32x16_bf16 v[152:167], v[44:47], v[112:115], v[120:135]
    ds_read_b128 v[112:115], v3 offset:48128
    v_exp_f32 v141, v141
    v_exp_f32 v142, v142
    v_exp_f32 v143, v143
    v_exp_f32 v144, v144
    v_exp_f32 v145, v145
    v_smfmac_f32_32x32x32_bf16 v[168:183], v[96:99], v[136:143], v9
    ds_read_b128 v[120:123], v0 offset:38400
    ds_read_b128 v[124:127], v0 offset:38400
    ds_read_b128 v[128:131], v0 offset:38400
    ds_read_b128 v[132:135], v0 offset:38400
    v_exp_f32 v146, v146
    v_exp_f32 v147, v147
    v_exp_f32 v148, v148
    v_exp_f32 v149, v149
    v_mfma_f32_16x16x32_bf16 v[208:211], v[224:227], v[240:243], v[208:211]
    buffer_load_dwordx4 v[224:227], v3, s[28:31], s43 offen offset:2048 sc1
    v_exp_f32 v150, v150
    v_exp_f32 v151, v151
    v_mfma_f32_32x32x16_bf16 v[184:199], v[116:119], v[116:119], 0
    v_exp_f32 v152, v152
    v_exp_f32 v153, v153
    v_smfmac_f32_32x32x32_bf16 v[168:183], v[100:103], v[144:151], v9
    v_exp_f32 v154, v154
    v_exp_f32 v155, v155
    v_exp_f32 v156, v156
    v_exp_f32 v157, v157
    v_exp_f32 v158, v158
    s_waitcnt lgkmcnt(0)
    v_mfma_f32_32x32x16_bf16 v[136:151], v[16:19], v[112:115], v[120:135]
    v_exp_f32 v159, v159
    v_exp_f32 v160, v160
    v_exp_f32 v161, v161
    v_exp_f32 v162, v162
    v_smfmac_f32_32x32x32_bf16 v[168:183], v[104:107], v[152:159], v9
    v_exp_f32 v163, v163
    v_exp_f32 v164, v164
    v_exp_f32 v165, v165
    v_mfma_f32_16x16x32_bf16 v[212:215], v[228:231], v[240:243], v[212:215]
    buffer_load_dwordx4 v[228:231], v3, s[28:31], s43 offen offset:3072 sc1
    v_exp_f32 v166, v166
    v_exp_f32 v167, v167
    v_exp_f32 v136, v136
    v_exp_f32 v137, v137
    v_smfmac_f32_32x32x32_bf16 v[168:183], v[108:111], v[160:167], v9
    s_waitcnt vmcnt(2)
    v_exp_f32 v138, v138
    v_exp_f32 v139, v139
    v_exp_f32 v140, v140
    v_mfma_f32_32x32x16_bf16 v[152:167], v[20:23], v[112:115], v[120:135]
    v_exp_f32 v141, v141
    v_exp_f32 v142, v142
    v_exp_f32 v143, v143
    v_exp_f32 v144, v144
    v_exp_f32 v145, v145
    v_smfmac_f32_32x32x32_bf16 v[184:199], v[48:51], v[136:143], v9
    s_setprio 1
    s_xor_b32 s46, s41, 45056
    buffer_load_dwordx4 v[16:19], v3, s[28:31], s46 offen offset:0 sc1
    v_exp_f32 v146, v146
    v_exp_f32 v147, v147
    v_exp_f32 v148, v148
    v_exp_f32 v149, v149
    v_mfma_f32_16x16x32_bf16 v[200:203], v[216:219], v[244:247], v[200:203]
    ds_write_b64 v14, v[168:169] offset:0
    s_xor_b32 s43, s41, 40960
    buffer_load_dwordx4 v[216:219], v3, s[28:31], s43 offen offset:0 sc1
    v_exp_f32 v150, v150
    v_exp_f32 v151, v151
    v_exp_f32 v152, v152
    v_exp_f32 v153, v153
    v_smfmac_f32_32x32x32_bf16 v[184:199], v[52:55], v[144:151], v9
    ds_write_b64 v14, v[170:171] offset:4096
    ds_write_b64 v14, v[172:173] offset:8192
    v_exp_f32 v154, v154
    v_exp_f32 v155, v155
    v_exp_f32 v156, v156
    v_mfma_f32_32x32x16_bf16 v[136:151], v[24:27], v[112:115], v[120:135]
    ds_write_b64 v14, v[174:175] offset:12288
    v_exp_f32 v157, v157
    v_exp_f32 v158, v158
    v_exp_f32 v159, v159
    v_exp_f32 v160, v160
    v_exp_f32 v161, v161
    v_smfmac_f32_32x32x32_bf16 v[184:199], v[56:59], v[152:159], v9
    ds_write_b32 v15, v176 offset:16384
    s_setprio 0
    buffer_load_dwordx4 v[20:23], v3, s[28:31], s46 offen offset:1024 sc1
    v_exp_f32 v162, v162
    v_exp_f32 v163, v163
    v_exp_f32 v164, v164
    v_exp_f32 v165, v165
    v_mfma_f32_16x16x32_bf16 v[204:207], v[220:223], v[244:247], v[204:207]
    buffer_load_dwordx4 v[220:223], v3, s[28:31], s43 offen offset:1024 sc1
    v_exp_f32 v166, v166
    v_exp_f32 v167, v167
    v_exp_f32 v136, v136
    v_exp_f32 v137, v137
    v_smfmac_f32_32x32x32_bf16 v[184:199], v[60:63], v[160:167], v9
    s_waitcnt vmcnt(4)
    v_exp_f32 v138, v138
    v_exp_f32 v139, v139
    v_exp_f32 v140, v140
    v_mfma_f32_32x32x16_bf16 v[152:167], v[28:31], v[112:115], v[120:135]
    v_exp_f32 v141, v141
    v_exp_f32 v142, v142
    v_exp_f32 v143, v143
    v_exp_f32 v144, v144
    v_exp_f32 v145, v145
    v_smfmac_f32_32x32x32_bf16 v[184:199], v[64:67], v[136:143], v9
    s_waitcnt lgkmcnt(0)
    s_barrier
    s_setprio 3
    buffer_load_dwordx4 v[24:27], v3, s[28:31], s46 offen offset:2048 sc1
    v_exp_f32 v146, v146
    v_exp_f32 v147, v147
    v_exp_f32 v148, v148
    v_exp_f32 v149, v149
    v_mfma_f32_16x16x32_bf16 v[208:211], v[224:227], v[244:247], v[208:211]
    buffer_load_dwordx4 v[224:227], v3, s[28:31], s43 offen offset:2048 sc1
    v_exp_f32 v150, v150
    v_exp_f32 v151, v151
    v_exp_f32 v152, v152
    v_exp_f32 v153, v153
    v_smfmac_f32_32x32x32_bf16 v[184:199], v[68:71], v[144:151], v9
    v_exp_f32 v154, v154
    v_exp_f32 v155, v155
    v_exp_f32 v156, v156
    v_mfma_f32_32x32x16_bf16 v[136:151], v[32:35], v[112:115], v[120:135]
    v_exp_f32 v157, v157
    v_exp_f32 v158, v158
    v_exp_f32 v159, v159
    v_exp_f32 v160, v160
    v_exp_f32 v161, v161
    v_smfmac_f32_32x32x32_bf16 v[184:199], v[72:75], v[152:159], v9
    ds_read_b128 v[240:243], v7 offset:39936
    buffer_load_dwordx4 v[28:31], v3, s[28:31], s46 offen offset:3072 sc1
    v_exp_f32 v162, v162
    v_exp_f32 v163, v163
    v_exp_f32 v164, v164
    v_exp_f32 v165, v165
    v_mfma_f32_16x16x32_bf16 v[212:215], v[228:231], v[244:247], v[212:215]
    buffer_load_dwordx4 v[228:231], v3, s[28:31], s43 offen offset:3072 sc1
    v_exp_f32 v166, v166
    v_exp_f32 v167, v167
    v_exp_f32 v136, v136
    v_exp_f32 v137, v137
    v_smfmac_f32_32x32x32_bf16 v[184:199], v[76:79], v[160:167], v9
    v_exp_f32 v138, v138
    v_exp_f32 v139, v139
    v_exp_f32 v140, v140
    v_mfma_f32_32x32x16_bf16 v[152:167], v[36:39], v[112:115], v[120:135]
    ds_read_b128 v[244:247], v7 offset:40448
    v_exp_f32 v141, v141
    v_exp_f32 v142, v142
    v_exp_f32 v143, v143
    v_exp_f32 v144, v144
    v_exp_f32 v145, v145
    v_smfmac_f32_32x32x32_bf16 v[184:199], v[80:83], v[136:143], v9
    s_waitcnt lgkmcnt(0)
    s_setprio 2
    v_exp_f32 v146, v146
    v_exp_f32 v147, v147
    v_exp_f32 v148, v148
    v_exp_f32 v149, v149
    s_waitcnt vmcnt(6)
    v_mfma_f32_16x16x32_bf16 v[200:203], v[216:219], v[240:243], v[200:203]
    s_xor_b32 s43, s41, 49152
    buffer_load_dwordx4 v[216:219], v3, s[28:31], s43 offen offset:0 sc1
    v_exp_f32 v150, v150
    v_exp_f32 v151, v151
    s_waitcnt vmcnt(5)
    v_mfma_f32_16x16x32_bf16 v[204:207], v[220:223], v[240:243], v[204:207]
    buffer_load_dwordx4 v[220:223], v3, s[28:31], s43 offen offset:1024 sc1
    v_exp_f32 v152, v152
    v_exp_f32 v153, v153
    v_smfmac_f32_32x32x32_bf16 v[184:199], v[84:87], v[144:151], v9
    v_exp_f32 v154, v154
    v_exp_f32 v155, v155
    v_exp_f32 v156, v156
    v_mfma_f32_32x32x16_bf16 v[136:151], v[40:43], v[112:115], v[120:135]
    v_exp_f32 v157, v157
    v_exp_f32 v158, v158
    v_exp_f32 v159, v159
    v_exp_f32 v160, v160
    v_exp_f32 v161, v161
    v_smfmac_f32_32x32x32_bf16 v[184:199], v[88:91], v[152:159], v9
    s_setprio 1
    v_exp_f32 v162, v162
    v_exp_f32 v163, v163
    v_exp_f32 v164, v164
    v_exp_f32 v165, v165
    s_waitcnt vmcnt(4)
    v_mfma_f32_16x16x32_bf16 v[208:211], v[224:227], v[240:243], v[208:211]
    buffer_load_dwordx4 v[224:227], v3, s[28:31], s43 offen offset:2048 sc1
    v_exp_f32 v166, v166
    v_exp_f32 v167, v167
    s_waitcnt vmcnt(3)
    v_mfma_f32_16x16x32_bf16 v[212:215], v[228:231], v[240:243], v[212:215]
    buffer_load_dwordx4 v[228:231], v3, s[28:31], s43 offen offset:3072 sc1
    v_exp_f32 v136, v136
    v_exp_f32 v137, v137
    v_smfmac_f32_32x32x32_bf16 v[184:199], v[92:95], v[160:167], v9
    s_xor_b32 s50, s41, 58368
    buffer_load_dwordx4 v[48:51], v3, s[28:31], s50 offen offset:0 sc1
    v_exp_f32 v138, v138
    v_exp_f32 v139, v139
    v_exp_f32 v140, v140
    v_mfma_f32_32x32x16_bf16 v[152:167], v[44:47], v[112:115], v[120:135]
    v_add_u32 v10, s42, v3
    v_exp_f32 v141, v141
    v_exp_f32 v142, v142
    v_exp_f32 v143, v143
    v_exp_f32 v144, v144
    v_exp_f32 v145, v145
    v_smfmac_f32_32x32x32_bf16 v[184:199], v[96:99], v[136:143], v9
    s_setprio 0
    buffer_load_dwordx4 v[52:55], v3, s[28:31], s50 offen offset:1024 sc1
    s_waitcnt lgkmcnt(0)
    s_barrier
    ds_read_b128 v[232:235], v7 offset:38912
    ds_read_b128 v[236:239], v7 offset:39424
    v_exp_f32 v146, v146
    v_exp_f32 v147, v147
    v_exp_f32 v148, v148
    v_exp_f32 v149, v149
    s_waitcnt vmcnt(13)
    v_mfma_f32_16x16x32_bf16 v[200:203], v[16:19], v[244:247], v[200:203]
    v_exp_f32 v150, v150
    v_exp_f32 v151, v151
    s_waitcnt vmcnt(11)
    v_mfma_f32_16x16x32_bf16 v[204:207], v[20:23], v[244:247], v[204:207]
    v_exp_f32 v152, v152
    v_exp_f32 v153, v153
    v_smfmac_f32_32x32x32_bf16 v[184:199], v[100:103], v[144:151], v9
    buffer_load_dwordx4 v[56:59], v3, s[28:31], s50 offen offset:2048 sc1
    v_exp_f32 v154, v154
    v_exp_f32 v155, v155
    v_exp_f32 v156, v156
    v_exp_f32 v157, v157
    v_exp_f32 v158, v158
    ds_read_b128 v[120:123], v10 offset:8192
    ds_read_b128 v[124:127], v10 offset:9216
    ds_read_b128 v[128:131], v10 offset:10240
    ds_read_b128 v[132:135], v10 offset:11264
    ds_read_b128 v[136:139], v10 offset:12288
    v_exp_f32 v159, v159
    v_exp_f32 v160, v160
    v_exp_f32 v161, v161
    v_exp_f32 v162, v162
    v_smfmac_f32_32x32x32_bf16 v[184:199], v[104:107], v[152:159], v9
    v_exp_f32 v163, v163
    v_exp_f32 v164, v164
    v_exp_f32 v165, v165
    s_waitcnt vmcnt(10)
    v_mfma_f32_16x16x32_bf16 v[208:211], v[24:27], v[244:247], v[208:211]
    v_exp_f32 v166, v166
    v_exp_f32 v167, v167
    s_waitcnt vmcnt(8)
    v_mfma_f32_16x16x32_bf16 v[212:215], v[28:31], v[244:247], v[212:215]
    s_branch B_tail
.p2align 3
B_young:
    s_nop 7
    v_exp_f32 v152, v152
    v_exp_f32 v153, v153
    v_smfmac_f32_32x32x32_bf16 v[184:199], v[84:87], v[144:151], v9
    v_pk_add_f32 v[232:233], v[232:233], v[234:235]
    v_pk_add_f32 v[236:237], v[236:237], v[238:239]
    v_pk_add_f32 v[168:169], v[168:169], v[170:171]
    v_pk_add_f32 v[172:173], v[172:173], v[174:175]
    v_pk_add_f32 v[176:177], v[176:177], v[178:179]
    v_pk_add_f32 v[180:181], v[180:181], v[182:183]
    v_pk_add_f32 v[232:233], v[232:233], v[236:237]
    v_pk_add_f32 v[168:169], v[168:169], v[172:173]
    v_add_f32 v232, v232, v233
    v_pk_add_f32 v[176:177], v[176:177], v[180:181]
    v_rcp_f32 v234, v232
    v_pk_add_f32 v[168:169], v[168:169], v[176:177]
    v_maximum3_f32 v233, |v168|, |v169|, |v169|
    v_pk_mul_f32 v[168:169], v[168:169], v[234:235] op_sel_hi:[1,0]
    v_maximum3_f32 v12, v12, v232, v233
    v_cvt_pk_bf16_f32 v168, v168, v169
    v_min_f32 v13, v13, v233
    ds_write_b32 v5, v168 offset:38912
    v_exp_f32 v154, v154
    v_exp_f32 v155, v155
    v_exp_f32 v156, v156
    v_mfma_f32_32x32x16_bf16 v[136:151], v[40:43], v[112:115], v[120:135]
    v_exp_f32 v157, v157
    v_exp_f32 v158, v158
    v_exp_f32 v159, v159
    v_exp_f32 v160, v160
    v_exp_f32 v161, v161
    v_smfmac_f32_32x32x32_bf16 v[184:199], v[88:91], v[152:159], v9
    s_setprio 2
    v_exp_f32 v162, v162
    v_exp_f32 v163, v163
    v_exp_f32 v164, v164
    v_exp_f32 v165, v165
    v_exp_f32 v166, v166
    v_exp_f32 v167, v167
    v_exp_f32 v136, v136
    v_exp_f32 v137, v137
    v_smfmac_f32_32x32x32_bf16 v[184:199], v[92:95], v[160:167], v9
    v_exp_f32 v138, v138
    v_exp_f32 v139, v139
    v_exp_f32 v140, v140
    v_mfma_f32_32x32x16_bf16 v[152:167], v[44:47], v[112:115], v[120:135]
    ds_read_b128 v[112:115], v3 offset:43008
    v_exp_f32 v141, v141
    v_exp_f32 v142, v142
    v_exp_f32 v143, v143
    v_exp_f32 v144, v144
    v_exp_f32 v145, v145
    v_smfmac_f32_32x32x32_bf16 v[184:199], v[96:99], v[136:143], v9
    ds_read_b128 v[120:123], v0 offset:35840
    ds_read_b128 v[124:127], v0 offset:35840
    ds_read_b128 v[128:131], v0 offset:35840
    ds_read_b128 v[132:135], v0 offset:35840
    v_exp_f32 v146, v146
    v_exp_f32 v147, v147
    v_exp_f32 v148, v148
    v_exp_f32 v149, v149
    v_exp_f32 v150, v150
    v_exp_f32 v151, v151
    v_mfma_f32_32x32x16_bf16 v[168:183], v[116:119], v[116:119], 0
    v_exp_f32 v152, v152
    v_exp_f32 v153, v153
    v_smfmac_f32_32x32x32_bf16 v[184:199], v[100:103], v[144:151], v9
    v_exp_f32 v154, v154
    v_exp_f32 v155, v155
    v_exp_f32 v156, v156
    v_exp_f32 v157, v157
    v_exp_f32 v158, v158
    s_waitcnt lgkmcnt(0)
    v_mfma_f32_32x32x16_bf16 v[136:151], v[16:19], v[112:115], v[120:135]
    v_exp_f32 v159, v159
    v_exp_f32 v160, v160
    v_exp_f32 v161, v161
    v_exp_f32 v162, v162
    v_smfmac_f32_32x32x32_bf16 v[184:199], v[104:107], v[152:159], v9
    v_exp_f32 v163, v163
    v_exp_f32 v164, v164
    v_exp_f32 v165, v165
    v_exp_f32 v166, v166
    v_exp_f32 v167, v167
    s_nop 1
    v_exp_f32 v136, v136
    v_exp_f32 v137, v137
    v_smfmac_f32_32x32x32_bf16 v[184:199], v[108:111], v[160:167], v9
    v_exp_f32 v138, v138
    v_exp_f32 v139, v139
    v_exp_f32 v140, v140
    v_mfma_f32_32x32x16_bf16 v[152:167], v[20:23], v[112:115], v[120:135]
    v_exp_f32 v141, v141
    v_exp_f32 v142, v142
    v_exp_f32 v143, v143
    v_exp_f32 v144, v144
    v_exp_f32 v145, v145
    v_smfmac_f32_32x32x32_bf16 v[168:183], v[48:51], v[136:143], v9
    s_setprio 1
    v_exp_f32 v146, v146
    v_exp_f32 v147, v147
    v_exp_f32 v148, v148
    v_exp_f32 v149, v149
    ds_write_b64 v14, v[184:185] offset:17408
    v_exp_f32 v150, v150
    v_exp_f32 v151, v151
    v_exp_f32 v152, v152
    v_exp_f32 v153, v153
    v_smfmac_f32_32x32x32_bf16 v[168:183], v[52:55], v[144:151], v9
    ds_write_b64 v14, v[186:187] offset:21504
    ds_write_b64 v14, v[188:189] offset:25600
    v_exp_f32 v154, v154
    v_exp_f32 v155, v155
    v_exp_f32 v156, v156
    v_mfma_f32_32x32x16_bf16 v[136:151], v[24:27], v[112:115], v[120:135]
    ds_write_b64 v14, v[190:191] offset:29696
    v_exp_f32 v157, v157
    v_exp_f32 v158, v158
    v_exp_f32 v159, v159
    v_exp_f32 v160, v160
    v_exp_f32 v161, v161
    v_smfmac_f32_32x32x32_bf16 v[168:183], v[56:59], v[152:159], v9
    ds_write_b32 v15, v192 offset:33792
    s_setprio 0
    v_exp_f32 v162, v162
    v_exp_f32 v163, v163
    v_exp_f32 v164, v164
    v_exp_f32 v165, v165
    v_exp_f32 v166, v166
    v_exp_f32 v167, v167
    v_exp_f32 v136, v136
    v_exp_f32 v137, v137
    v_smfmac_f32_32x32x32_bf16 v[168:183], v[60:63], v[160:167], v9
    v_exp_f32 v138, v138
    v_exp_f32 v139, v139
    v_exp_f32 v140, v140
    v_mfma_f32_32x32x16_bf16 v[152:167], v[28:31], v[112:115], v[120:135]
    v_exp_f32 v141, v141
    v_exp_f32 v142, v142
    v_exp_f32 v143, v143
    v_exp_f32 v144, v144
    v_exp_f32 v145, v145
    v_smfmac_f32_32x32x32_bf16 v[168:183], v[64:67], v[136:143], v9
    s_waitcnt lgkmcnt(0)
    s_barrier
    s_setprio 3
    v_exp_f32 v146, v146
    v_exp_f32 v147, v147
    v_exp_f32 v148, v148
    v_exp_f32 v149, v149
    v_exp_f32 v150, v150
    v_exp_f32 v151, v151
    v_exp_f32 v152, v152
    v_exp_f32 v153, v153
    v_smfmac_f32_32x32x32_bf16 v[168:183], v[68:71], v[144:151], v9
    ds_read_b128 v[232:235], v0 offset:33792
    ds_read_b128 v[236:239], v0 offset:34304
    v_exp_f32 v154, v154
    v_exp_f32 v155, v155
    v_exp_f32 v156, v156
    v_mfma_f32_32x32x16_bf16 v[136:151], v[32:35], v[112:115], v[120:135]
    ds_read_b128 v[184:187], v6 offset:17408
    v_exp_f32 v157, v157
    v_exp_f32 v158, v158
    v_exp_f32 v159, v159
    v_exp_f32 v160, v160
    v_exp_f32 v161, v161
    v_smfmac_f32_32x32x32_bf16 v[168:183], v[72:75], v[152:159], v9
    ds_read_b128 v[188:191], v6 offset:18432
    ds_read_b128 v[240:243], v7 offset:38912
    s_add_u32 m0, s42, 8192
    s_xor_b32 s46, s41, 53248
    v_exp_f32 v162, v162
    v_exp_f32 v163, v163
    v_exp_f32 v164, v164
    v_exp_f32 v165, v165
    v_exp_f32 v166, v166
    v_exp_f32 v167, v167
    v_exp_f32 v136, v136
    v_exp_f32 v137, v137
    v_smfmac_f32_32x32x32_bf16 v[168:183], v[76:79], v[160:167], v9
    ds_read_b128 v[192:195], v6 offset:19456
    ds_read_b128 v[196:199], v6 offset:20480
    s_waitcnt vmcnt(2)
    v_exp_f32 v138, v138
    v_exp_f32 v139, v139
    v_exp_f32 v140, v140
    v_mfma_f32_32x32x16_bf16 v[152:167], v[36:39], v[112:115], v[120:135]
    ds_read_b128 v[244:247], v7 offset:39424
    buffer_load_dwordx4 v3, s[28:31], s46 offen offset:0 sc1 lds
    v_exp_f32 v141, v141
    v_exp_f32 v142, v142
    v_exp_f32 v143, v143
    v_exp_f32 v144, v144
    v_exp_f32 v145, v145
    v_smfmac_f32_32x32x32_bf16 v[168:183], v[80:83], v[136:143], v9
    s_waitcnt lgkmcnt(0)
    v_exp_f32 v146, v146
    v_exp_f32 v147, v147
    v_exp_f32 v148, v148
    v_exp_f32 v149, v149
    v_mfma_f32_16x16x32_bf16 v[200:203], v[216:219], v[240:243], 0
    s_xor_b32 s43, s41, 4096
    buffer_load_dwordx4 v[216:219], v3, s[28:31], s43 offen offset:0 sc1
    v_exp_f32 v150, v150
    v_exp_f32 v151, v151
    v_exp_f32 v152, v152
    v_exp_f32 v153, v153
    v_smfmac_f32_32x32x32_bf16 v[168:183], v[84:87], v[144:151], v9
    v_pk_add_f32 v[232:233], v[232:233], v[234:235]
    v_pk_add_f32 v[236:237], v[236:237], v[238:239]
    v_pk_add_f32 v[184:185], v[184:185], v[186:187]
    v_pk_add_f32 v[188:189], v[188:189], v[190:191]
    v_pk_add_f32 v[192:193], v[192:193], v[194:195]
    v_pk_add_f32 v[196:197], v[196:197], v[198:199]
    v_pk_add_f32 v[232:233], v[232:233], v[236:237]
    v_pk_add_f32 v[184:185], v[184:185], v[188:189]
    v_add_f32 v232, v232, v233
    v_pk_add_f32 v[192:193], v[192:193], v[196:197]
    v_rcp_f32 v234, v232
    v_pk_add_f32 v[184:185], v[184:185], v[192:193]
    v_maximum3_f32 v233, |v184|, |v185|, |v185|
    v_pk_mul_f32 v[184:185], v[184:185], v[234:235] op_sel_hi:[1,0]
    v_maximum3_f32 v12, v12, v232, v233
    v_cvt_pk_bf16_f32 v184, v184, v185
    v_min_f32 v13, v13, v233
    ds_write_b32 v5, v184 offset:39936
    v_exp_f32 v154, v154
    v_exp_f32 v155, v155
    v_exp_f32 v156, v156
    v_mfma_f32_32x32x16_bf16 v[136:151], v[40:43], v[112:115], v[120:135]
    buffer_load_dwordx4 v3, s[28:31], s46 offen offset:1024 sc1 lds
    v_exp_f32 v157, v157
    v_exp_f32 v158, v158
    v_exp_f32 v159, v159
    v_exp_f32 v160, v160
    v_exp_f32 v161, v161
    v_smfmac_f32_32x32x32_bf16 v[168:183], v[88:91], v[152:159], v9
    s_setprio 2
    v_exp_f32 v162, v162
    v_exp_f32 v163, v163
    v_exp_f32 v164, v164
    v_exp_f32 v165, v165
    v_mfma_f32_16x16x32_bf16 v[204:207], v[220:223], v[240:243], 0
    buffer_load_dwordx4 v[220:223], v3, s[28:31], s43 offen offset:1024 sc1
    v_exp_f32 v166, v166
    v_exp_f32 v167, v167
    v_exp_f32 v136, v136
    v_exp_f32 v137, v137
    v_smfmac_f32_32x32x32_bf16 v[168:183], v[92:95], v[160:167], v9
    s_waitcnt vmcnt(4)
    v_exp_f32 v138, v138
    v_exp_f32 v139, v139
    v_exp_f32 v140, v140
    v_mfma_f32_32x32x16_bf16 v[152:167], v[44:47], v[112:115], v[120:135]
    ds_read_b128 v[112:115], v3 offset:44032
    v_exp_f32 v141, v141
    v_exp_f32 v142, v142
    v_exp_f32 v143, v143
    v_exp_f32 v144, v144
    v_exp_f32 v145, v145
    v_smfmac_f32_32x32x32_bf16 v[168:183], v[96:99], v[136:143], v9
    ds_read_b128 v[120:123], v0 offset:36352
    ds_read_b128 v[124:127], v0 offset:36352
    ds_read_b128 v[128:131], v0 offset:36352
    ds_read_b128 v[132:135], v0 offset:36352
    v_exp_f32 v146, v146
    v_exp_f32 v147, v147
    v_exp_f32 v148, v148
    v_exp_f32 v149, v149
    v_mfma_f32_16x16x32_bf16 v[208:211], v[224:227], v[240:243], 0
    buffer_load_dwordx4 v[224:227], v3, s[28:31], s43 offen offset:2048 sc1
    v_exp_f32 v150, v150
    v_exp_f32 v151, v151
    v_mfma_f32_32x32x16_bf16 v[184:199], v[116:119], v[116:119], 0
    v_exp_f32 v152, v152
    v_exp_f32 v153, v153
    v_smfmac_f32_32x32x32_bf16 v[168:183], v[100:103], v[144:151], v9
    v_exp_f32 v154, v154
    v_exp_f32 v155, v155
    v_exp_f32 v156, v156
    v_exp_f32 v157, v157
    v_exp_f32 v158, v158
    s_waitcnt lgkmcnt(0)
    v_mfma_f32_32x32x16_bf16 v[136:151], v[16:19], v[112:115], v[120:135]
    buffer_load_dwordx4 v3, s[28:31], s46 offen offset:2048 sc1 lds
    v_exp_f32 v159, v159
    v_exp_f32 v160, v160
    v_exp_f32 v161, v161
    v_exp_f32 v162, v162
    v_smfmac_f32_32x32x32_bf16 v[168:183], v[104:107], v[152:159], v9
    v_exp_f32 v163, v163
    v_exp_f32 v164, v164
    v_exp_f32 v165, v165
    v_mfma_f32_16x16x32_bf16 v[212:215], v[228:231], v[240:243], 0
    buffer_load_dwordx4 v[228:231], v3, s[28:31], s43 offen offset:3072 sc1
    v_exp_f32 v166, v166
    v_exp_f32 v167, v167
    v_exp_f32 v136, v136
    v_exp_f32 v137, v137
    v_smfmac_f32_32x32x32_bf16 v[168:183], v[108:111], v[160:167], v9
    s_waitcnt vmcnt(3)
    v_exp_f32 v138, v138
    v_exp_f32 v139, v139
    v_exp_f32 v140, v140
    v_mfma_f32_32x32x16_bf16 v[152:167], v[20:23], v[112:115], v[120:135]
    buffer_load_dwordx4 v3, s[28:31], s46 offen offset:3072 sc1 lds
    v_exp_f32 v141, v141
    v_exp_f32 v142, v142
    v_exp_f32 v143, v143
    v_exp_f32 v144, v144
    v_exp_f32 v145, v145
    v_smfmac_f32_32x32x32_bf16 v[184:199], v[48:51], v[136:143], v9
    s_setprio 1
    s_add_u32 m0, s42, 12288
    s_xor_b32 s46, s41, 57344
    v_exp_f32 v146, v146
    v_exp_f32 v147, v147
    v_exp_f32 v148, v148
    v_exp_f32 v149, v149
    v_mfma_f32_16x16x32_bf16 v[200:203], v[216:219], v[244:247], v[200:203]
    ds_write_b64 v14, v[168:169] offset:0
    s_xor_b32 s43, s41, 8192
    buffer_load_dwordx4 v[216:219], v3, s[28:31], s43 offen offset:0 sc1
    v_exp_f32 v150, v150
    v_exp_f32 v151, v151
    v_exp_f32 v152, v152
    v_exp_f32 v153, v153
    v_smfmac_f32_32x32x32_bf16 v[184:199], v[52:55], v[144:151], v9
    ds_write_b64 v14, v[170:171] offset:4096
    ds_write_b64 v14, v[172:173] offset:8192
    v_exp_f32 v154, v154
    v_exp_f32 v155, v155
    v_exp_f32 v156, v156
    v_mfma_f32_32x32x16_bf16 v[136:151], v[24:27], v[112:115], v[120:135]
    ds_write_b64 v14, v[174:175] offset:12288
    buffer_load_dwordx4 v3, s[28:31], s46 offen offset:0 sc1 lds
    v_exp_f32 v157, v157
    v_exp_f32 v158, v158
    v_exp_f32 v159, v159
    v_exp_f32 v160, v160
    v_exp_f32 v161, v161
    v_smfmac_f32_32x32x32_bf16 v[184:199], v[56:59], v[152:159], v9
    ds_write_b32 v15, v176 offset:16384
    s_setprio 0
    v_exp_f32 v162, v162
    v_exp_f32 v163, v163
    v_exp_f32 v164, v164
    v_exp_f32 v165, v165
    v_mfma_f32_16x16x32_bf16 v[204:207], v[220:223], v[244:247], v[204:207]
    buffer_load_dwordx4 v[220:223], v3, s[28:31], s43 offen offset:1024 sc1
    v_exp_f32 v166, v166
    v_exp_f32 v167, v167
    v_exp_f32 v136, v136
    v_exp_f32 v137, v137
    v_smfmac_f32_32x32x32_bf16 v[184:199], v[60:63], v[160:167], v9
    s_waitcnt vmcnt(4)
    s_lshl_b32 s13, s52, 4
    s_mov_b32 s46, s53
    v_exp_f32 v138, v138
    v_exp_f32 v139, v139
    v_exp_f32 v140, v140
    v_mfma_f32_32x32x16_bf16 v[152:167], v[28:31], v[112:115], v[120:135]
    v_exp_f32 v141, v141
    v_exp_f32 v142, v142
    v_exp_f32 v143, v143
    v_exp_f32 v144, v144
    v_exp_f32 v145, v145
    v_smfmac_f32_32x32x32_bf16 v[184:199], v[64:67], v[136:143], v9
    s_waitcnt lgkmcnt(0)
    s_barrier
    s_setprio 3
    s_add_u32 m0, s42, 0
    v_exp_f32 v146, v146
    v_exp_f32 v147, v147
    v_exp_f32 v148, v148
    v_exp_f32 v149, v149
    v_mfma_f32_16x16x32_bf16 v[208:211], v[224:227], v[244:247], v[208:211]
    buffer_load_dwordx4 v[224:227], v3, s[28:31], s43 offen offset:2048 sc1
    v_exp_f32 v150, v150
    v_exp_f32 v151, v151
    v_exp_f32 v152, v152
    v_exp_f32 v153, v153
    v_smfmac_f32_32x32x32_bf16 v[184:199], v[68:71], v[144:151], v9
    ds_read_b128 v[232:235], v0 offset:16384
    ds_read_b128 v[236:239], v0 offset:16896
    v_exp_f32 v154, v154
    v_exp_f32 v155, v155
    v_exp_f32 v156, v156
    v_mfma_f32_32x32x16_bf16 v[136:151], v[32:35], v[112:115], v[120:135]
    ds_read_b128 v[168:171], v6 offset:0
    v_exp_f32 v157, v157
    v_exp_f32 v158, v158
    v_exp_f32 v159, v159
    v_exp_f32 v160, v160
    v_exp_f32 v161, v161
    v_smfmac_f32_32x32x32_bf16 v[184:199], v[72:75], v[152:159], v9
    ds_read_b128 v[172:175], v6 offset:1024
    ds_read_b128 v[240:243], v7 offset:39936
    v_exp_f32 v162, v162
    v_exp_f32 v163, v163
    v_exp_f32 v164, v164
    v_exp_f32 v165, v165
    v_mfma_f32_16x16x32_bf16 v[212:215], v[228:231], v[244:247], v[212:215]
    buffer_load_dwordx4 v[228:231], v3, s[28:31], s43 offen offset:3072 sc1
    v_exp_f32 v166, v166
    v_exp_f32 v167, v167
    v_exp_f32 v136, v136
    v_exp_f32 v137, v137
    v_smfmac_f32_32x32x32_bf16 v[184:199], v[76:79], v[160:167], v9
    ds_read_b128 v[176:179], v6 offset:2048
    ds_read_b128 v[180:183], v6 offset:3072
    s_waitcnt vmcnt(2)
    v_exp_f32 v138, v138
    v_exp_f32 v139, v139
    v_exp_f32 v140, v140
    v_mfma_f32_32x32x16_bf16 v[152:167], v[36:39], v[112:115], v[120:135]
    ds_read_b128 v[244:247], v7 offset:40448
    v_exp_f32 v141, v141
    v_exp_f32 v142, v142
    v_exp_f32 v143, v143
    v_exp_f32 v144, v144
    v_exp_f32 v145, v145
    v_smfmac_f32_32x32x32_bf16 v[184:199], v[80:83], v[136:143], v9
    s_waitcnt lgkmcnt(0)
    v_exp_f32 v146, v146
    v_exp_f32 v147, v147
    v_exp_f32 v148, v148
    v_exp_f32 v149, v149
    v_mfma_f32_16x16x32_bf16 v[200:203], v[216:219], v[240:243], v[200:203]
    s_xor_b32 s43, s41, 12288
    buffer_load_dwordx4 v[216:219], v3, s[28:31], s43 offen offset:0 sc1
    v_exp_f32 v150, v150
    v_exp_f32 v151, v151
    v_exp_f32 v152, v152
    v_exp_f32 v153, v153
    v_smfmac_f32_32x32x32_bf16 v[184:199], v[84:87], v[144:151], v9
    v_pk_add_f32 v[232:233], v[232:233], v[234:235]
    v_pk_add_f32 v[236:237], v[236:237], v[238:239]
    v_pk_add_f32 v[168:169], v[168:169], v[170:171]
    v_pk_add_f32 v[172:173], v[172:173], v[174:175]
    v_pk_add_f32 v[176:177], v[176:177], v[178:179]
    v_pk_add_f32 v[180:181], v[180:181], v[182:183]
    v_pk_add_f32 v[232:233], v[232:233], v[236:237]
    v_pk_add_f32 v[168:169], v[168:169], v[172:173]
    v_add_f32 v232, v232, v233
    v_pk_add_f32 v[176:177], v[176:177], v[180:181]
    v_rcp_f32 v234, v232
    v_pk_add_f32 v[168:169], v[168:169], v[176:177]
    v_maximum3_f32 v233, |v168|, |v169|, |v169|
    v_pk_mul_f32 v[168:169], v[168:169], v[234:235] op_sel_hi:[1,0]
    v_maximum3_f32 v12, v12, v232, v233
    v_cvt_pk_bf16_f32 v168, v168, v169
    v_min_f32 v13, v13, v233
    ds_write_b32 v5, v168 offset:38912
    v_exp_f32 v154, v154
    v_exp_f32 v155, v155
    v_exp_f32 v156, v156
    v_mfma_f32_32x32x16_bf16 v[136:151], v[40:43], v[112:115], v[120:135]
    buffer_load_dwordx4 v8, s[56:59], s46 offen lds
    v_exp_f32 v157, v157
    v_exp_f32 v158, v158
    v_exp_f32 v159, v159
    v_exp_f32 v160, v160
    v_exp_f32 v161, v161
    v_smfmac_f32_32x32x32_bf16 v[184:199], v[88:91], v[152:159], v9
    s_setprio 2
    v_exp_f32 v162, v162
    v_exp_f32 v163, v163
    v_exp_f32 v164, v164
    v_exp_f32 v165, v165
    v_mfma_f32_16x16x32_bf16 v[204:207], v[220:223], v[240:243], v[204:207]
    buffer_load_dwordx4 v[220:223], v3, s[28:31], s43 offen offset:1024 sc1
    v_exp_f32 v166, v166
    v_exp_f32 v167, v167
    v_exp_f32 v136, v136
    v_exp_f32 v137, v137
    v_smfmac_f32_32x32x32_bf16 v[184:199], v[92:95], v[160:167], v9
    s_waitcnt vmcnt(3)
    s_add_u32 m0, s42, 1024
    s_add_u32 s46, s46, s13
    v_exp_f32 v138, v138
    v_exp_f32 v139, v139
    v_exp_f32 v140, v140
    v_mfma_f32_32x32x16_bf16 v[152:167], v[44:47], v[112:115], v[120:135]
    ds_read_b128 v[112:115], v3 offset:45056
    v_exp_f32 v141, v141
    v_exp_f32 v142, v142
    v_exp_f32 v143, v143
    v_exp_f32 v144, v144
    v_exp_f32 v145, v145
    v_smfmac_f32_32x32x32_bf16 v[184:199], v[96:99], v[136:143], v9
    ds_read_b128 v[120:123], v0 offset:36864
    ds_read_b128 v[124:127], v0 offset:36864
    ds_read_b128 v[128:131], v0 offset:36864
    ds_read_b128 v[132:135], v0 offset:36864
    v_exp_f32 v146, v146
    v_exp_f32 v147, v147
    v_exp_f32 v148, v148
    v_exp_f32 v149, v149
    v_mfma_f32_16x16x32_bf16 v[208:211], v[224:227], v[240:243], v[208:211]
    buffer_load_dwordx4 v[224:227], v3, s[28:31], s43 offen offset:2048 sc1
    v_exp_f32 v150, v150
    v_exp_f32 v151, v151
    v_mfma_f32_32x32x16_bf16 v[168:183], v[116:119], v[116:119], 0
    v_exp_f32 v152, v152
    v_exp_f32 v153, v153
    v_smfmac_f32_32x32x32_bf16 v[184:199], v[100:103], v[144:151], v9
    v_exp_f32 v154, v154
    v_exp_f32 v155, v155
    v_exp_f32 v156, v156
    v_exp_f32 v157, v157
    v_exp_f32 v158, v158
    s_waitcnt lgkmcnt(0)
    v_mfma_f32_32x32x16_bf16 v[136:151], v[16:19], v[112:115], v[120:135]
    buffer_load_dwordx4 v8, s[56:59], s46 offen lds
    v_exp_f32 v159, v159
    v_exp_f32 v160, v160
    v_exp_f32 v161, v161
    v_exp_f32 v162, v162
    v_smfmac_f32_32x32x32_bf16 v[184:199], v[104:107], v[152:159], v9
    s_add_u32 m0, s42, 2048
    s_add_u32 s46, s46, s13
    v_exp_f32 v163, v163
    v_exp_f32 v164, v164
    v_exp_f32 v165, v165
    v_mfma_f32_16x16x32_bf16 v[212:215], v[228:231], v[240:243], v[212:215]
    buffer_load_dwordx4 v[228:231], v3, s[28:31], s43 offen offset:3072 sc1
    v_exp_f32 v166, v166
    v_exp_f32 v167, v167
    v_exp_f32 v136, v136
    v_exp_f32 v137, v137
    v_smfmac_f32_32x32x32_bf16 v[184:199], v[108:111], v[160:167], v9
    s_waitcnt vmcnt(3)
    v_exp_f32 v138, v138
    v_exp_f32 v139, v139
    v_exp_f32 v140, v140
    v_mfma_f32_32x32x16_bf16 v[152:167], v[20:23], v[112:115], v[120:135]
    buffer_load_dwordx4 v8, s[56:59], s46 offen lds
    v_exp_f32 v141, v141
    v_exp_f32 v142, v142
    v_exp_f32 v143, v143
    v_exp_f32 v144, v144
    v_exp_f32 v145, v145
    v_smfmac_f32_32x32x32_bf16 v[168:183], v[48:51], v[136:143], v9
    s_setprio 1
    v_exp_f32 v146, v146
    v_exp_f32 v147, v147
    v_exp_f32 v148, v148
    v_exp_f32 v149, v149
    v_mfma_f32_16x16x32_bf16 v[200:203], v[216:219], v[244:247], v[200:203]
    ds_write_b64 v14, v[184:185] offset:17408
    s_xor_b32 s43, s41, 16384
    buffer_load_dwordx4 v[216:219], v3, s[28:31], s43 offen offset:0 sc1
    v_exp_f32 v150, v150
    v_exp_f32 v151, v151
    v_exp_f32 v152, v152
    v_exp_f32 v153, v153
    v_smfmac_f32_32x32x32_bf16 v[168:183], v[52:55], v[144:151], v9
    ds_write_b64 v14, v[186:187] offset:21504
    ds_write_b64 v14, v[188:189] offset:25600
    v_exp_f32 v154, v154
    v_exp_f32 v155, v155
    v_exp_f32 v156, v156
    v_mfma_f32_32x32x16_bf16 v[136:151], v[24:27], v[112:115], v[120:135]
    ds_write_b64 v14, v[190:191] offset:29696
    v_exp_f32 v157, v157
    v_exp_f32 v158, v158
    v_exp_f32 v159, v159
    v_exp_f32 v160, v160
    v_exp_f32 v161, v161
    v_smfmac_f32_32x32x32_bf16 v[168:183], v[56:59], v[152:159], v9
    ds_write_b32 v15, v192 offset:33792
    s_setprio 0
    v_exp_f32 v162, v162
    v_exp_f32 v163, v163
    v_exp_f32 v164, v164
    v_exp_f32 v165, v165
    v_mfma_f32_16x16x32_bf16 v[204:207], v[220:223], v[244:247], v[204:207]
    buffer_load_dwordx4 v[220:223], v3, s[28:31], s43 offen offset:1024 sc1
    v_exp_f32 v166, v166
    v_exp_f32 v167, v167
    v_exp_f32 v136, v136
    v_exp_f32 v137, v137
    v_smfmac_f32_32x32x32_bf16 v[168:183], v[60:63], v[160:167], v9
    s_waitcnt vmcnt(3)
    v_exp_f32 v138, v138
    v_exp_f32 v139, v139
    v_exp_f32 v140, v140
    v_mfma_f32_32x32x16_bf16 v[152:167], v[28:31], v[112:115], v[120:135]
    v_exp_f32 v141, v141
    v_exp_f32 v142, v142
    v_exp_f32 v143, v143
    v_exp_f32 v144, v144
    v_exp_f32 v145, v145
    v_smfmac_f32_32x32x32_bf16 v[168:183], v[64:67], v[136:143], v9
    s_waitcnt lgkmcnt(0)
    s_barrier
    s_setprio 3
    s_add_u32 m0, s42, 3072
    s_add_u32 s46, s46, s13
    v_exp_f32 v146, v146
    v_exp_f32 v147, v147
    v_exp_f32 v148, v148
    v_exp_f32 v149, v149
    v_mfma_f32_16x16x32_bf16 v[208:211], v[224:227], v[244:247], v[208:211]
    buffer_load_dwordx4 v[224:227], v3, s[28:31], s43 offen offset:2048 sc1
    v_exp_f32 v150, v150
    v_exp_f32 v151, v151
    v_exp_f32 v152, v152
    v_exp_f32 v153, v153
    v_smfmac_f32_32x32x32_bf16 v[168:183], v[68:71], v[144:151], v9
    ds_read_b128 v[232:235], v0 offset:33792
    ds_read_b128 v[236:239], v0 offset:34304
    v_exp_f32 v154, v154
    v_exp_f32 v155, v155
    v_exp_f32 v156, v156
    v_mfma_f32_32x32x16_bf16 v[136:151], v[32:35], v[112:115], v[120:135]
    ds_read_b128 v[184:187], v6 offset:17408
    v_exp_f32 v157, v157
    v_exp_f32 v158, v158
    v_exp_f32 v159, v159
    v_exp_f32 v160, v160
    v_exp_f32 v161, v161
    v_smfmac_f32_32x32x32_bf16 v[168:183], v[72:75], v[152:159], v9
    ds_read_b128 v[188:191], v6 offset:18432
    ds_read_b128 v[240:243], v7 offset:38912
    v_exp_f32 v162, v162
    v_exp_f32 v163, v163
    v_exp_f32 v164, v164
    v_exp_f32 v165, v165
    v_mfma_f32_16x16x32_bf16 v[212:215], v[228:231], v[244:247], v[212:215]
    buffer_load_dwordx4 v[228:231], v3, s[28:31], s43 offen offset:3072 sc1
    v_exp_f32 v166, v166
    v_exp_f32 v167, v167
    v_exp_f32 v136, v136
    v_exp_f32 v137, v137
    v_smfmac_f32_32x32x32_bf16 v[168:183], v[76:79], v[160:167], v9
    ds_read_b128 v[192:195], v6 offset:19456
    ds_read_b128 v[196:199], v6 offset:20480
    s_waitcnt vmcnt(2)
    v_exp_f32 v138, v138
    v_exp_f32 v139, v139
    v_exp_f32 v140, v140
    v_mfma_f32_32x32x16_bf16 v[152:167], v[36:39], v[112:115], v[120:135]
    ds_read_b128 v[244:247], v7 offset:39424
    v_exp_f32 v141, v141
    v_exp_f32 v142, v142
    v_exp_f32 v143, v143
    v_exp_f32 v144, v144
    v_exp_f32 v145, v145
    v_smfmac_f32_32x32x32_bf16 v[168:183], v[80:83], v[136:143], v9
    s_waitcnt lgkmcnt(0)
    v_exp_f32 v146, v146
    v_exp_f32 v147, v147
    v_exp_f32 v148, v148
    v_exp_f32 v149, v149
    v_mfma_f32_16x16x32_bf16 v[200:203], v[216:219], v[240:243], v[200:203]
    s_xor_b32 s43, s41, 20480
    buffer_load_dwordx4 v[216:219], v3, s[28:31], s43 offen offset:0 sc1
    v_exp_f32 v150, v150
    v_exp_f32 v151, v151
    v_exp_f32 v152, v152
    v_exp_f32 v153, v153
    v_smfmac_f32_32x32x32_bf16 v[168:183], v[84:87], v[144:151], v9
    v_pk_add_f32 v[232:233], v[232:233], v[234:235]
    v_pk_add_f32 v[236:237], v[236:237], v[238:239]
    v_pk_add_f32 v[184:185], v[184:185], v[186:187]
    v_pk_add_f32 v[188:189], v[188:189], v[190:191]
    v_pk_add_f32 v[192:193], v[192:193], v[194:195]
    v_pk_add_f32 v[196:197], v[196:197], v[198:199]
    v_pk_add_f32 v[232:233], v[232:233], v[236:237]
    v_pk_add_f32 v[184:185], v[184:185], v[188:189]
    v_add_f32 v232, v232, v233
    v_pk_add_f32 v[192:193], v[192:193], v[196:197]
    v_rcp_f32 v234, v232
    v_pk_add_f32 v[184:185], v[184:185], v[192:193]
    v_maximum3_f32 v233, |v184|, |v185|, |v185|
    v_pk_mul_f32 v[184:185], v[184:185], v[234:235] op_sel_hi:[1,0]
    v_maximum3_f32 v12, v12, v232, v233
    v_cvt_pk_bf16_f32 v184, v184, v185
    v_min_f32 v13, v13, v233
    ds_write_b32 v5, v184 offset:39936
    v_exp_f32 v154, v154
    v_exp_f32 v155, v155
    v_exp_f32 v156, v156
    v_mfma_f32_32x32x16_bf16 v[136:151], v[40:43], v[112:115], v[120:135]
    buffer_load_dwordx4 v8, s[56:59], s46 offen lds
    v_exp_f32 v157, v157
    v_exp_f32 v158, v158
    v_exp_f32 v159, v159
    v_exp_f32 v160, v160
    v_exp_f32 v161, v161
    v_smfmac_f32_32x32x32_bf16 v[168:183], v[88:91], v[152:159], v9
    s_setprio 2
    v_exp_f32 v162, v162
    v_exp_f32 v163, v163
    v_exp_f32 v164, v164
    v_exp_f32 v165, v165
    v_mfma_f32_16x16x32_bf16 v[204:207], v[220:223], v[240:243], v[204:207]
    buffer_load_dwordx4 v[220:223], v3, s[28:31], s43 offen offset:1024 sc1
    v_exp_f32 v166, v166
    v_exp_f32 v167, v167
    v_exp_f32 v136, v136
    v_exp_f32 v137, v137
    v_smfmac_f32_32x32x32_bf16 v[168:183], v[92:95], v[160:167], v9
    s_waitcnt vmcnt(3)
    s_add_u32 m0, s42, 4096
    s_add_u32 s46, s46, s13
    v_exp_f32 v138, v138
    v_exp_f32 v139, v139
    v_exp_f32 v140, v140
    v_mfma_f32_32x32x16_bf16 v[152:167], v[44:47], v[112:115], v[120:135]
    ds_read_b128 v[112:115], v3 offset:46080
    v_exp_f32 v141, v141
    v_exp_f32 v142, v142
    v_exp_f32 v143, v143
    v_exp_f32 v144, v144
    v_exp_f32 v145, v145
    v_smfmac_f32_32x32x32_bf16 v[168:183], v[96:99], v[136:143], v9
    ds_read_b128 v[120:123], v0 offset:37376
    ds_read_b128 v[124:127], v0 offset:37376
    ds_read_b128 v[128:131], v0 offset:37376
    ds_read_b128 v[132:135], v0 offset:37376
    v_exp_f32 v146, v146
    v_exp_f32 v147, v147
    v_exp_f32 v148, v148
    v_exp_f32 v149, v149
    v_mfma_f32_16x16x32_bf16 v[208:211], v[224:227], v[240:243], v[208:211]
    buffer_load_dwordx4 v[224:227], v3, s[28:31], s43 offen offset:2048 sc1
    v_exp_f32 v150, v150
    v_exp_f32 v151, v151
    v_mfma_f32_32x32x16_bf16 v[184:199], v[116:119], v[116:119], 0
    v_exp_f32 v152, v152
    v_exp_f32 v153, v153
    v_smfmac_f32_32x32x32_bf16 v[168:183], v[100:103], v[144:151], v9
    v_exp_f32 v154, v154
    v_exp_f32 v155, v155
    v_exp_f32 v156, v156
    v_exp_f32 v157, v157
    v_exp_f32 v158, v158
    s_waitcnt lgkmcnt(0)
    v_mfma_f32_32x32x16_bf16 v[136:151], v[16:19], v[112:115], v[120:135]
    buffer_load_dwordx4 v8, s[56:59], s46 offen lds
    v_exp_f32 v159, v159
    v_exp_f32 v160, v160
    v_exp_f32 v161, v161
    v_exp_f32 v162, v162
    v_smfmac_f32_32x32x32_bf16 v[168:183], v[104:107], v[152:159], v9
    s_add_u32 m0, s42, 5120
    s_add_u32 s46, s46, s13
    v_exp_f32 v163, v163
    v_exp_f32 v164, v164
    v_exp_f32 v165, v165
    v_mfma_f32_16x16x32_bf16 v[212:215], v[228:231], v[240:243], v[212:215]
    buffer_load_dwordx4 v[228:231], v3, s[28:31], s43 offen offset:3072 sc1
    v_exp_f32 v166, v166
    v_exp_f32 v167, v167
    v_exp_f32 v136, v136
    v_exp_f32 v137, v137
    v_smfmac_f32_32x32x32_bf16 v[168:183], v[108:111], v[160:167], v9
    s_waitcnt vmcnt(3)
    v_exp_f32 v138, v138
    v_exp_f32 v139, v139
    v_exp_f32 v140, v140
    v_mfma_f32_32x32x16_bf16 v[152:167], v[20:23], v[112:115], v[120:135]
    buffer_load_dwordx4 v8, s[56:59], s46 offen lds
    v_exp_f32 v141, v141
    v_exp_f32 v142, v142
    v_exp_f32 v143, v143
    v_exp_f32 v144, v144
    v_exp_f32 v145, v145
    v_smfmac_f32_32x32x32_bf16 v[184:199], v[48:51], v[136:143], v9
    s_setprio 1
    v_exp_f32 v146, v146
    v_exp_f32 v147, v147
    v_exp_f32 v148, v148
    v_exp_f32 v149, v149
    v_mfma_f32_16x16x32_bf16 v[200:203], v[216:219], v[244:247], v[200:203]
    ds_write_b64 v14, v[168:169] offset:0
    s_xor_b32 s43, s41, 24576
    buffer_load_dwordx4 v[216:219], v3, s[28:31], s43 offen offset:0 sc1
    v_exp_f32 v150, v150
    v_exp_f32 v151, v151
    v_exp_f32 v152, v152
    v_exp_f32 v153, v153
    v_smfmac_f32_32x32x32_bf16 v[184:199], v[52:55], v[144:151], v9
    ds_write_b64 v14, v[170:171] offset:4096
    ds_write_b64 v14, v[172:173] offset:8192
    v_exp_f32 v154, v154
    v_exp_f32 v155, v155
    v_exp_f32 v156, v156
    v_mfma_f32_32x32x16_bf16 v[136:151], v[24:27], v[112:115], v[120:135]
    ds_write_b64 v14, v[174:175] offset:12288
    v_exp_f32 v157, v157
    v_exp_f32 v158, v158
    v_exp_f32 v159, v159
    v_exp_f32 v160, v160
    v_exp_f32 v161, v161
    v_smfmac_f32_32x32x32_bf16 v[184:199], v[56:59], v[152:159], v9
    ds_write_b32 v15, v176 offset:16384
    s_setprio 0
    v_exp_f32 v162, v162
    v_exp_f32 v163, v163
    v_exp_f32 v164, v164
    v_exp_f32 v165, v165
    v_mfma_f32_16x16x32_bf16 v[204:207], v[220:223], v[244:247], v[204:207]
    buffer_load_dwordx4 v[220:223], v3, s[28:31], s43 offen offset:1024 sc1
    v_exp_f32 v166, v166
    v_exp_f32 v167, v167
    v_exp_f32 v136, v136
    v_exp_f32 v137, v137
    v_smfmac_f32_32x32x32_bf16 v[184:199], v[60:63], v[160:167], v9
    s_waitcnt vmcnt(3)
    v_exp_f32 v138, v138
    v_exp_f32 v139, v139
    v_exp_f32 v140, v140
    v_mfma_f32_32x32x16_bf16 v[152:167], v[28:31], v[112:115], v[120:135]
    v_exp_f32 v141, v141
    v_exp_f32 v142, v142
    v_exp_f32 v143, v143
    v_exp_f32 v144, v144
    v_exp_f32 v145, v145
    v_smfmac_f32_32x32x32_bf16 v[184:199], v[64:67], v[136:143], v9
    s_waitcnt lgkmcnt(0)
    s_barrier
    s_setprio 3
    s_add_u32 m0, s42, 6144
    s_add_u32 s46, s46, s13
    v_exp_f32 v146, v146
    v_exp_f32 v147, v147
    v_exp_f32 v148, v148
    v_exp_f32 v149, v149
    v_mfma_f32_16x16x32_bf16 v[208:211], v[224:227], v[244:247], v[208:211]
    buffer_load_dwordx4 v[224:227], v3, s[28:31], s43 offen offset:2048 sc1
    v_exp_f32 v150, v150
    v_exp_f32 v151, v151
    v_exp_f32 v152, v152
    v_exp_f32 v153, v153
    v_smfmac_f32_32x32x32_bf16 v[184:199], v[68:71], v[144:151], v9
    ds_read_b128 v[232:235], v0 offset:16384
    ds_read_b128 v[236:239], v0 offset:16896
    v_exp_f32 v154, v154
    v_exp_f32 v155, v155
    v_exp_f32 v156, v156
    v_mfma_f32_32x32x16_bf16 v[136:151], v[32:35], v[112:115], v[120:135]
    ds_read_b128 v[168:171], v6 offset:0
    v_exp_f32 v157, v157
    v_exp_f32 v158, v158
    v_exp_f32 v159, v159
    v_exp_f32 v160, v160
    v_exp_f32 v161, v161
    v_smfmac_f32_32x32x32_bf16 v[184:199], v[72:75], v[152:159], v9
    ds_read_b128 v[172:175], v6 offset:1024
    ds_read_b128 v[240:243], v7 offset:39936
    v_exp_f32 v162, v162
    v_exp_f32 v163, v163
    v_exp_f32 v164, v164
    v_exp_f32 v165, v165
    v_mfma_f32_16x16x32_bf16 v[212:215], v[228:231], v[244:247], v[212:215]
    buffer_load_dwordx4 v[228:231], v3, s[28:31], s43 offen offset:3072 sc1
    v_exp_f32 v166, v166
    v_exp_f32 v167, v167
    v_exp_f32 v136, v136
    v_exp_f32 v137, v137
    v_smfmac_f32_32x32x32_bf16 v[184:199], v[76:79], v[160:167], v9
    ds_read_b128 v[176:179], v6 offset:2048
    ds_read_b128 v[180:183], v6 offset:3072
    s_waitcnt vmcnt(2)
    v_exp_f32 v138, v138
    v_exp_f32 v139, v139
    v_exp_f32 v140, v140
    v_mfma_f32_32x32x16_bf16 v[152:167], v[36:39], v[112:115], v[120:135]
    ds_read_b128 v[244:247], v7 offset:40448
    v_exp_f32 v141, v141
    v_exp_f32 v142, v142
    v_exp_f32 v143, v143
    v_exp_f32 v144, v144
    v_exp_f32 v145, v145
    v_smfmac_f32_32x32x32_bf16 v[184:199], v[80:83], v[136:143], v9
    s_waitcnt lgkmcnt(0)
    v_exp_f32 v146, v146
    v_exp_f32 v147, v147
    v_exp_f32 v148, v148
    v_exp_f32 v149, v149
    v_mfma_f32_16x16x32_bf16 v[200:203], v[216:219], v[240:243], v[200:203]
    s_xor_b32 s43, s41, 28672
    buffer_load_dwordx4 v[216:219], v3, s[28:31], s43 offen offset:0 sc1
    v_exp_f32 v150, v150
    v_exp_f32 v151, v151
    v_exp_f32 v152, v152
    v_exp_f32 v153, v153
    v_smfmac_f32_32x32x32_bf16 v[184:199], v[84:87], v[144:151], v9
    v_pk_add_f32 v[232:233], v[232:233], v[234:235]
    v_pk_add_f32 v[236:237], v[236:237], v[238:239]
    v_pk_add_f32 v[168:169], v[168:169], v[170:171]
    v_pk_add_f32 v[172:173], v[172:173], v[174:175]
    v_pk_add_f32 v[176:177], v[176:177], v[178:179]
    v_pk_add_f32 v[180:181], v[180:181], v[182:183]
    v_pk_add_f32 v[232:233], v[232:233], v[236:237]
    v_pk_add_f32 v[168:169], v[168:169], v[172:173]
    v_add_f32 v232, v232, v233
    v_pk_add_f32 v[176:177], v[176:177], v[180:181]
    v_rcp_f32 v234, v232
    v_pk_add_f32 v[168:169], v[168:169], v[176:177]
    v_maximum3_f32 v233, |v168|, |v169|, |v169|
    v_pk_mul_f32 v[168:169], v[168:169], v[234:235] op_sel_hi:[1,0]
    v_maximum3_f32 v12, v12, v232, v233
    v_cvt_pk_bf16_f32 v168, v168, v169
    v_min_f32 v13, v13, v233
    ds_write_b32 v5, v168 offset:38912
    v_exp_f32 v154, v154
    v_exp_f32 v155, v155
    v_exp_f32 v156, v156
    v_mfma_f32_32x32x16_bf16 v[136:151], v[40:43], v[112:115], v[120:135]
    buffer_load_dwordx4 v8, s[56:59], s46 offen lds
    v_exp_f32 v157, v157
    v_exp_f32 v158, v158
    v_exp_f32 v159, v159
    v_exp_f32 v160, v160
    v_exp_f32 v161, v161
    v_smfmac_f32_32x32x32_bf16 v[184:199], v[88:91], v[152:159], v9
    s_setprio 2
    v_exp_f32 v162, v162
    v_exp_f32 v163, v163
    v_exp_f32 v164, v164
    v_exp_f32 v165, v165
    v_mfma_f32_16x16x32_bf16 v[204:207], v[220:223], v[240:243], v[204:207]
    buffer_load_dwordx4 v[220:223], v3, s[28:31], s43 offen offset:1024 sc1
    v_exp_f32 v166, v166
    v_exp_f32 v167, v167
    v_exp_f32 v136, v136
    v_exp_f32 v137, v137
    v_smfmac_f32_32x32x32_bf16 v[184:199], v[92:95], v[160:167], v9
    s_waitcnt vmcnt(3)
    s_add_u32 m0, s42, 7168
    s_add_u32 s46, s46, s13
    v_exp_f32 v138, v138
    v_exp_f32 v139, v139
    v_exp_f32 v140, v140
    v_mfma_f32_32x32x16_bf16 v[152:167], v[44:47], v[112:115], v[120:135]
    ds_read_b128 v[112:115], v3 offset:47104
    v_exp_f32 v141, v141
    v_exp_f32 v142, v142
    v_exp_f32 v143, v143
    v_exp_f32 v144, v144
    v_exp_f32 v145, v145
    v_smfmac_f32_32x32x32_bf16 v[184:199], v[96:99], v[136:143], v9
    ds_read_b128 v[120:123], v0 offset:37888
    ds_read_b128 v[124:127], v0 offset:37888
    ds_read_b128 v[128:131], v0 offset:37888
    ds_read_b128 v[132:135], v0 offset:37888
    v_exp_f32 v146, v146
    v_exp_f32 v147, v147
    v_exp_f32 v148, v148
    v_exp_f32 v149, v149
    v_mfma_f32_16x16x32_bf16 v[208:211], v[224:227], v[240:243], v[208:211]
    buffer_load_dwordx4 v[224:227], v3, s[28:31], s43 offen offset:2048 sc1
    v_exp_f32 v150, v150
    v_exp_f32 v151, v151
    v_mfma_f32_32x32x16_bf16 v[168:183], v[116:119], v[116:119], 0
    v_exp_f32 v152, v152
    v_exp_f32 v153, v153
    v_smfmac_f32_32x32x32_bf16 v[184:199], v[100:103], v[144:151], v9
    v_exp_f32 v154, v154
    v_exp_f32 v155, v155
    v_exp_f32 v156, v156
    v_exp_f32 v157, v157
    v_exp_f32 v158, v158
    s_waitcnt lgkmcnt(0)
    v_mfma_f32_32x32x16_bf16 v[136:151], v[16:19], v[112:115], v[120:135]
    buffer_load_dwordx4 v8, s[56:59], s46 offen lds
    v_exp_f32 v159, v159
    v_exp_f32 v160, v160
    v_exp_f32 v161, v161
    v_exp_f32 v162, v162
    v_smfmac_f32_32x32x32_bf16 v[184:199], v[104:107], v[152:159], v9
    v_exp_f32 v163, v163
    v_exp_f32 v164, v164
    v_exp_f32 v165, v165
    v_mfma_f32_16x16x32_bf16 v[212:215], v[228:231], v[240:243], v[212:215]
    buffer_load_dwordx4 v[228:231], v3, s[28:31], s43 offen offset:3072 sc1
    v_exp_f32 v166, v166
    v_exp_f32 v167, v167
    v_exp_f32 v136, v136
    v_exp_f32 v137, v137
    v_smfmac_f32_32x32x32_bf16 v[184:199], v[108:111], v[160:167], v9
    s_waitcnt vmcnt(3)
    v_exp_f32 v138, v138
    v_exp_f32 v139, v139
    v_exp_f32 v140, v140
    v_mfma_f32_32x32x16_bf16 v[152:167], v[20:23], v[112:115], v[120:135]
    v_exp_f32 v141, v141
    v_exp_f32 v142, v142
    v_exp_f32 v143, v143
    v_exp_f32 v144, v144
    v_exp_f32 v145, v145
    v_smfmac_f32_32x32x32_bf16 v[168:183], v[48:51], v[136:143], v9
    s_setprio 1
    v_exp_f32 v146, v146
    v_exp_f32 v147, v147
    v_exp_f32 v148, v148
    v_exp_f32 v149, v149
    v_mfma_f32_16x16x32_bf16 v[200:203], v[216:219], v[244:247], v[200:203]
    ds_write_b64 v14, v[184:185] offset:17408
    s_xor_b32 s43, s41, 32768
    buffer_load_dwordx4 v[216:219], v3, s[28:31], s43 offen offset:0 sc1
    v_exp_f32 v150, v150
    v_exp_f32 v151, v151
    v_exp_f32 v152, v152
    v_exp_f32 v153, v153
    v_smfmac_f32_32x32x32_bf16 v[168:183], v[52:55], v[144:151], v9
    ds_write_b64 v14, v[186:187] offset:21504
    ds_write_b64 v14, v[188:189] offset:25600
    v_exp_f32 v154, v154
    v_exp_f32 v155, v155
    v_exp_f32 v156, v156
    v_mfma_f32_32x32x16_bf16 v[136:151], v[24:27], v[112:115], v[120:135]
    ds_write_b64 v14, v[190:191] offset:29696
    v_exp_f32 v157, v157
    v_exp_f32 v158, v158
    v_exp_f32 v159, v159
    v_exp_f32 v160, v160
    v_exp_f32 v161, v161
    v_smfmac_f32_32x32x32_bf16 v[168:183], v[56:59], v[152:159], v9
    ds_write_b32 v15, v192 offset:33792
    s_setprio 0
    v_exp_f32 v162, v162
    v_exp_f32 v163, v163
    v_exp_f32 v164, v164
    v_exp_f32 v165, v165
    v_mfma_f32_16x16x32_bf16 v[204:207], v[220:223], v[244:247], v[204:207]
    buffer_load_dwordx4 v[220:223], v3, s[28:31], s43 offen offset:1024 sc1
    v_exp_f32 v166, v166
    v_exp_f32 v167, v167
    v_exp_f32 v136, v136
    v_exp_f32 v137, v137
    v_smfmac_f32_32x32x32_bf16 v[168:183], v[60:63], v[160:167], v9
    s_waitcnt vmcnt(2)
    v_exp_f32 v138, v138
    v_exp_f32 v139, v139
    v_exp_f32 v140, v140
    v_mfma_f32_32x32x16_bf16 v[152:167], v[28:31], v[112:115], v[120:135]
    v_exp_f32 v141, v141
    v_exp_f32 v142, v142
    v_exp_f32 v143, v143
    v_exp_f32 v144, v144
    v_exp_f32 v145, v145
    v_smfmac_f32_32x32x32_bf16 v[168:183], v[64:67], v[136:143], v9
    s_waitcnt lgkmcnt(0)
    s_barrier
    s_setprio 3
    v_exp_f32 v146, v146
    v_exp_f32 v147, v147
    v_exp_f32 v148, v148
    v_exp_f32 v149, v149
    v_mfma_f32_16x16x32_bf16 v[208:211], v[224:227], v[244:247], v[208:211]
    buffer_load_dwordx4 v[224:227], v3, s[28:31], s43 offen offset:2048 sc1
    v_exp_f32 v150, v150
    v_exp_f32 v151, v151
    v_exp_f32 v152, v152
    v_exp_f32 v153, v153
    v_smfmac_f32_32x32x32_bf16 v[168:183], v[68:71], v[144:151], v9
    ds_read_b128 v[232:235], v0 offset:33792
    ds_read_b128 v[236:239], v0 offset:34304
    v_exp_f32 v154, v154
    v_exp_f32 v155, v155
    v_exp_f32 v156, v156
    v_mfma_f32_32x32x16_bf16 v[136:151], v[32:35], v[112:115], v[120:135]
    ds_read_b128 v[184:187], v6 offset:17408
    v_exp_f32 v157, v157
    v_exp_f32 v158, v158
    v_exp_f32 v159, v159
    v_exp_f32 v160, v160
    v_exp_f32 v161, v161
    v_smfmac_f32_32x32x32_bf16 v[168:183], v[72:75], v[152:159], v9
    ds_read_b128 v[188:191], v6 offset:18432
    ds_read_b128 v[240:243], v7 offset:38912
    v_exp_f32 v162, v162
    v_exp_f32 v163, v163
    v_exp_f32 v164, v164
    v_exp_f32 v165, v165
    v_mfma_f32_16x16x32_bf16 v[212:215], v[228:231], v[244:247], v[212:215]
    buffer_load_dwordx4 v[228:231], v3, s[28:31], s43 offen offset:3072 sc1
    v_exp_f32 v166, v166
    v_exp_f32 v167, v167
    v_exp_f32 v136, v136
    v_exp_f32 v137, v137
    v_smfmac_f32_32x32x32_bf16 v[168:183], v[76:79], v[160:167], v9
    ds_read_b128 v[192:195], v6 offset:19456
    ds_read_b128 v[196:199], v6 offset:20480
    s_waitcnt vmcnt(2)
    v_exp_f32 v138, v138
    v_exp_f32 v139, v139
    v_exp_f32 v140, v140
    v_mfma_f32_32x32x16_bf16 v[152:167], v[36:39], v[112:115], v[120:135]
    ds_read_b128 v[244:247], v7 offset:39424
    v_exp_f32 v141, v141
    v_exp_f32 v142, v142
    v_exp_f32 v143, v143
    v_exp_f32 v144, v144
    v_exp_f32 v145, v145
    v_smfmac_f32_32x32x32_bf16 v[168:183], v[80:83], v[136:143], v9
    s_waitcnt lgkmcnt(0)
    buffer_load_dwordx4 v[252:255], v250, s[20:23], s10 offen
    v_exp_f32 v146, v146
    v_exp_f32 v147, v147
    v_exp_f32 v148, v148
    v_exp_f32 v149, v149
    v_mfma_f32_16x16x32_bf16 v[200:203], v[216:219], v[240:243], v[200:203]
    s_xor_b32 s43, s41, 36864
    buffer_load_dwordx4 v[216:219], v3, s[28:31], s43 offen offset:0 sc1
    v_exp_f32 v150, v150
    v_exp_f32 v151, v151
    v_exp_f32 v152, v152
    v_exp_f32 v153, v153
    v_smfmac_f32_32x32x32_bf16 v[168:183], v[84:87], v[144:151], v9
    v_pk_add_f32 v[232:233], v[232:233], v[234:235]
    v_pk_add_f32 v[236:237], v[236:237], v[238:239]
    v_pk_add_f32 v[184:185], v[184:185], v[186:187]
    v_pk_add_f32 v[188:189], v[188:189], v[190:191]
    v_pk_add_f32 v[192:193], v[192:193], v[194:195]
    v_pk_add_f32 v[196:197], v[196:197], v[198:199]
    v_pk_add_f32 v[232:233], v[232:233], v[236:237]
    v_pk_add_f32 v[184:185], v[184:185], v[188:189]
    v_add_f32 v232, v232, v233
    v_pk_add_f32 v[192:193], v[192:193], v[196:197]
    v_rcp_f32 v234, v232
    v_pk_add_f32 v[184:185], v[184:185], v[192:193]
    v_maximum3_f32 v233, |v184|, |v185|, |v185|
    v_pk_mul_f32 v[184:185], v[184:185], v[234:235] op_sel_hi:[1,0]
    v_maximum3_f32 v12, v12, v232, v233
    v_cvt_pk_bf16_f32 v184, v184, v185
    v_min_f32 v13, v13, v233
    ds_write_b32 v5, v184 offset:39936
    v_exp_f32 v154, v154
    v_exp_f32 v155, v155
    v_exp_f32 v156, v156
    v_mfma_f32_32x32x16_bf16 v[136:151], v[40:43], v[112:115], v[120:135]
    v_exp_f32 v157, v157
    v_exp_f32 v158, v158
    v_exp_f32 v159, v159
    v_exp_f32 v160, v160
    v_exp_f32 v161, v161
    v_smfmac_f32_32x32x32_bf16 v[168:183], v[88:91], v[152:159], v9
    s_setprio 2
    buffer_load_dwordx4 v[248:251], v251, s[16:19], s40 offen
    v_exp_f32 v162, v162
    v_exp_f32 v163, v163
    v_exp_f32 v164, v164
    v_exp_f32 v165, v165
    v_mfma_f32_16x16x32_bf16 v[204:207], v[220:223], v[240:243], v[204:207]
    buffer_load_dwordx4 v[220:223], v3, s[28:31], s43 offen offset:1024 sc1
    v_exp_f32 v166, v166
    v_exp_f32 v167, v167
    v_exp_f32 v136, v136
    v_exp_f32 v137, v137
    v_smfmac_f32_32x32x32_bf16 v[168:183], v[92:95], v[160:167], v9
    s_waitcnt vmcnt(4)
    v_exp_f32 v138, v138
    v_exp_f32 v139, v139
    v_exp_f32 v140, v140
    v_mfma_f32_32x32x16_bf16 v[152:167], v[44:47], v[112:115], v[120:135]
    ds_read_b128 v[112:115], v3 offset:48128
    v_exp_f32 v141, v141
    v_exp_f32 v142, v142
    v_exp_f32 v143, v143
    v_exp_f32 v144, v144
    v_exp_f32 v145, v145
    v_smfmac_f32_32x32x32_bf16 v[168:183], v[96:99], v[136:143], v9
    ds_read_b128 v[120:123], v0 offset:38400
    ds_read_b128 v[124:127], v0 offset:38400
    ds_read_b128 v[128:131], v0 offset:38400
    ds_read_b128 v[132:135], v0 offset:38400
    v_exp_f32 v146, v146
    v_exp_f32 v147, v147
    v_exp_f32 v148, v148
    v_exp_f32 v149, v149
    v_mfma_f32_16x16x32_bf16 v[208:211], v[224:227], v[240:243], v[208:211]
    buffer_load_dwordx4 v[224:227], v3, s[28:31], s43 offen offset:2048 sc1
    v_exp_f32 v150, v150
    v_exp_f32 v151, v151
    v_mfma_f32_32x32x16_bf16 v[184:199], v[116:119], v[116:119], 0
    v_exp_f32 v152, v152
    v_exp_f32 v153, v153
    v_smfmac_f32_32x32x32_bf16 v[168:183], v[100:103], v[144:151], v9
    v_exp_f32 v154, v154
    v_exp_f32 v155, v155
    v_exp_f32 v156, v156
    v_exp_f32 v157, v157
    v_exp_f32 v158, v158
    s_waitcnt lgkmcnt(0)
    v_mfma_f32_32x32x16_bf16 v[136:151], v[16:19], v[112:115], v[120:135]
    v_exp_f32 v159, v159
    v_exp_f32 v160, v160
    v_exp_f32 v161, v161
    v_exp_f32 v162, v162
    v_smfmac_f32_32x32x32_bf16 v[168:183], v[104:107], v[152:159], v9
    v_exp_f32 v163, v163
    v_exp_f32 v164, v164
    v_exp_f32 v165, v165
    v_mfma_f32_16x16x32_bf16 v[212:215], v[228:231], v[240:243], v[212:215]
    buffer_load_dwordx4 v[228:231], v3, s[28:31], s43 offen offset:3072 sc1
    v_exp_f32 v166, v166
    v_exp_f32 v167, v167
    v_exp_f32 v136, v136
    v_exp_f32 v137, v137
    v_smfmac_f32_32x32x32_bf16 v[168:183], v[108:111], v[160:167], v9
    s_waitcnt vmcnt(2)
    v_exp_f32 v138, v138
    v_exp_f32 v139, v139
    v_exp_f32 v140, v140
    v_mfma_f32_32x32x16_bf16 v[152:167], v[20:23], v[112:115], v[120:135]
    v_exp_f32 v141, v141
    v_exp_f32 v142, v142
    v_exp_f32 v143, v143
    v_exp_f32 v144, v144
    v_exp_f32 v145, v145
    v_smfmac_f32_32x32x32_bf16 v[184:199], v[48:51], v[136:143], v9
    s_setprio 1
    s_xor_b32 s46, s41, 45056
    buffer_load_dwordx4 v[16:19], v3, s[28:31], s46 offen offset:0 sc1
    v_exp_f32 v146, v146
    v_exp_f32 v147, v147
    v_exp_f32 v148, v148
    v_exp_f32 v149, v149
    v_mfma_f32_16x16x32_bf16 v[200:203], v[216:219], v[244:247], v[200:203]
    ds_write_b64 v14, v[168:169] offset:0
    s_xor_b32 s43, s41, 40960
    buffer_load_dwordx4 v[216:219], v3, s[28:31], s43 offen offset:0 sc1
    v_exp_f32 v150, v150
    v_exp_f32 v151, v151
    v_exp_f32 v152, v152
    v_exp_f32 v153, v153
    v_smfmac_f32_32x32x32_bf16 v[184:199], v[52:55], v[144:151], v9
    ds_write_b64 v14, v[170:171] offset:4096
    ds_write_b64 v14, v[172:173] offset:8192
    v_exp_f32 v154, v154
    v_exp_f32 v155, v155
    v_exp_f32 v156, v156
    v_mfma_f32_32x32x16_bf16 v[136:151], v[24:27], v[112:115], v[120:135]
    ds_write_b64 v14, v[174:175] offset:12288
    v_exp_f32 v157, v157
    v_exp_f32 v158, v158
    v_exp_f32 v159, v159
    v_exp_f32 v160, v160
    v_exp_f32 v161, v161
    v_smfmac_f32_32x32x32_bf16 v[184:199], v[56:59], v[152:159], v9
    ds_write_b32 v15, v176 offset:16384
    s_setprio 0
    buffer_load_dwordx4 v[20:23], v3, s[28:31], s46 offen offset:1024 sc1
    v_exp_f32 v162, v162
    v_exp_f32 v163, v163
    v_exp_f32 v164, v164
    v_exp_f32 v165, v165
    v_mfma_f32_16x16x32_bf16 v[204:207], v[220:223], v[244:247], v[204:207]
    buffer_load_dwordx4 v[220:223], v3, s[28:31], s43 offen offset:1024 sc1
    v_exp_f32 v166, v166
    v_exp_f32 v167, v167
    v_exp_f32 v136, v136
    v_exp_f32 v137, v137
    v_smfmac_f32_32x32x32_bf16 v[184:199], v[60:63], v[160:167], v9
    s_waitcnt vmcnt(4)
    v_exp_f32 v138, v138
    v_exp_f32 v139, v139
    v_exp_f32 v140, v140
    v_mfma_f32_32x32x16_bf16 v[152:167], v[28:31], v[112:115], v[120:135]
    v_exp_f32 v141, v141
    v_exp_f32 v142, v142
    v_exp_f32 v143, v143
    v_exp_f32 v144, v144
    v_exp_f32 v145, v145
    v_smfmac_f32_32x32x32_bf16 v[184:199], v[64:67], v[136:143], v9
    s_waitcnt lgkmcnt(0)
    s_barrier
    s_setprio 3
    buffer_load_dwordx4 v[24:27], v3, s[28:31], s46 offen offset:2048 sc1
    v_exp_f32 v146, v146
    v_exp_f32 v147, v147
    v_exp_f32 v148, v148
    v_exp_f32 v149, v149
    v_mfma_f32_16x16x32_bf16 v[208:211], v[224:227], v[244:247], v[208:211]
    buffer_load_dwordx4 v[224:227], v3, s[28:31], s43 offen offset:2048 sc1
    v_exp_f32 v150, v150
    v_exp_f32 v151, v151
    v_exp_f32 v152, v152
    v_exp_f32 v153, v153
    v_smfmac_f32_32x32x32_bf16 v[184:199], v[68:71], v[144:151], v9
    ds_read_b128 v[232:235], v0 offset:16384
    ds_read_b128 v[236:239], v0 offset:16896
    v_exp_f32 v154, v154
    v_exp_f32 v155, v155
    v_exp_f32 v156, v156
    v_mfma_f32_32x32x16_bf16 v[136:151], v[32:35], v[112:115], v[120:135]
    ds_read_b128 v[168:171], v6 offset:0
    v_exp_f32 v157, v157
    v_exp_f32 v158, v158
    v_exp_f32 v159, v159
    v_exp_f32 v160, v160
    v_exp_f32 v161, v161
    v_smfmac_f32_32x32x32_bf16 v[184:199], v[72:75], v[152:159], v9
    ds_read_b128 v[172:175], v6 offset:1024
    ds_read_b128 v[240:243], v7 offset:39936
    buffer_load_dwordx4 v[28:31], v3, s[28:31], s46 offen offset:3072 sc1
    v_exp_f32 v162, v162
    v_exp_f32 v163, v163
    v_exp_f32 v164, v164
    v_exp_f32 v165, v165
    v_mfma_f32_16x16x32_bf16 v[212:215], v[228:231], v[244:247], v[212:215]
    buffer_load_dwordx4 v[228:231], v3, s[28:31], s43 offen offset:3072 sc1
    v_exp_f32 v166, v166
    v_exp_f32 v167, v167
    v_exp_f32 v136, v136
    v_exp_f32 v137, v137
    v_smfmac_f32_32x32x32_bf16 v[184:199], v[76:79], v[160:167], v9
    ds_read_b128 v[176:179], v6 offset:2048
    ds_read_b128 v[180:183], v6 offset:3072
    v_exp_f32 v138, v138
    v_exp_f32 v139, v139
    v_exp_f32 v140, v140
    v_mfma_f32_32x32x16_bf16 v[152:167], v[36:39], v[112:115], v[120:135]
    ds_read_b128 v[244:247], v7 offset:40448
    v_exp_f32 v141, v141
    v_exp_f32 v142, v142
    v_exp_f32 v143, v143
    v_exp_f32 v144, v144
    v_exp_f32 v145, v145
    v_smfmac_f32_32x32x32_bf16 v[184:199], v[80:83], v[136:143], v9
    s_waitcnt lgkmcnt(0)
    s_setprio 2
    v_exp_f32 v146, v146
    v_exp_f32 v147, v147
    v_exp_f32 v148, v148
    v_exp_f32 v149, v149
    s_waitcnt vmcnt(6)
    v_mfma_f32_16x16x32_bf16 v[200:203], v[216:219], v[240:243], v[200:203]
    s_xor_b32 s43, s41, 49152
    buffer_load_dwordx4 v[216:219], v3, s[28:31], s43 offen offset:0 sc1
    v_exp_f32 v150, v150
    v_exp_f32 v151, v151
    s_waitcnt vmcnt(5)
    v_mfma_f32_16x16x32_bf16 v[204:207], v[220:223], v[240:243], v[204:207]
    buffer_load_dwordx4 v[220:223], v3, s[28:31], s43 offen offset:1024 sc1
    v_exp_f32 v152, v152
    v_exp_f32 v153, v153
    v_smfmac_f32_32x32x32_bf16 v[184:199], v[84:87], v[144:151], v9
    v_pk_add_f32 v[232:233], v[232:233], v[234:235]
    v_pk_add_f32 v[236:237], v[236:237], v[238:239]
    v_pk_add_f32 v[168:169], v[168:169], v[170:171]
    v_pk_add_f32 v[172:173], v[172:173], v[174:175]
    v_pk_add_f32 v[176:177], v[176:177], v[178:179]
    v_pk_add_f32 v[180:181], v[180:181], v[182:183]
    v_pk_add_f32 v[232:233], v[232:233], v[236:237]
    v_pk_add_f32 v[168:169], v[168:169], v[172:173]
    v_add_f32 v232, v232, v233
    v_pk_add_f32 v[176:177], v[176:177], v[180:181]
    v_rcp_f32 v234, v232
    v_pk_add_f32 v[168:169], v[168:169], v[176:177]
    v_maximum3_f32 v233, |v168|, |v169|, |v169|
    v_pk_mul_f32 v[168:169], v[168:169], v[234:235] op_sel_hi:[1,0]
    v_maximum3_f32 v12, v12, v232, v233
    v_cvt_pk_bf16_f32 v168, v168, v169
    v_min_f32 v13, v13, v233
    ds_write_b32 v5, v168 offset:38912
    v_exp_f32 v154, v154
    v_exp_f32 v155, v155
    v_exp_f32 v156, v156
    v_mfma_f32_32x32x16_bf16 v[136:151], v[40:43], v[112:115], v[120:135]
    v_exp_f32 v157, v157
    v_exp_f32 v158, v158
    v_exp_f32 v159, v159
    v_exp_f32 v160, v160
    v_exp_f32 v161, v161
    v_smfmac_f32_32x32x32_bf16 v[184:199], v[88:91], v[152:159], v9
    s_setprio 1
    v_exp_f32 v162, v162
    v_exp_f32 v163, v163
    v_exp_f32 v164, v164
    v_exp_f32 v165, v165
    s_waitcnt vmcnt(4)
    v_mfma_f32_16x16x32_bf16 v[208:211], v[224:227], v[240:243], v[208:211]
    buffer_load_dwordx4 v[224:227], v3, s[28:31], s43 offen offset:2048 sc1
    v_exp_f32 v166, v166
    v_exp_f32 v167, v167
    s_waitcnt vmcnt(3)
    v_mfma_f32_16x16x32_bf16 v[212:215], v[228:231], v[240:243], v[212:215]
    buffer_load_dwordx4 v[228:231], v3, s[28:31], s43 offen offset:3072 sc1
    v_exp_f32 v136, v136
    v_exp_f32 v137, v137
    v_smfmac_f32_32x32x32_bf16 v[184:199], v[92:95], v[160:167], v9
    s_xor_b32 s50, s41, 58368
    buffer_load_dwordx4 v[48:51], v3, s[28:31], s50 offen offset:0 sc1
    v_exp_f32 v138, v138
    v_exp_f32 v139, v139
    v_exp_f32 v140, v140
    v_mfma_f32_32x32x16_bf16 v[152:167], v[44:47], v[112:115], v[120:135]
    v_add_u32 v10, s42, v3
    v_exp_f32 v141, v141
    v_exp_f32 v142, v142
    v_exp_f32 v143, v143
    v_exp_f32 v144, v144
    v_exp_f32 v145, v145
    v_smfmac_f32_32x32x32_bf16 v[184:199], v[96:99], v[136:143], v9
    s_setprio 0
    buffer_load_dwordx4 v[52:55], v3, s[28:31], s50 offen offset:1024 sc1
    s_waitcnt lgkmcnt(0)
    s_barrier
    ds_read_b128 v[232:235], v7 offset:38912
    ds_read_b128 v[236:239], v7 offset:39424
    v_exp_f32 v146, v146
    v_exp_f32 v147, v147
    v_exp_f32 v148, v148
    v_exp_f32 v149, v149
    s_waitcnt vmcnt(13)
    v_mfma_f32_16x16x32_bf16 v[200:203], v[16:19], v[244:247], v[200:203]
    v_exp_f32 v150, v150
    v_exp_f32 v151, v151
    s_waitcnt vmcnt(11)
    v_mfma_f32_16x16x32_bf16 v[204:207], v[20:23], v[244:247], v[204:207]
    v_exp_f32 v152, v152
    v_exp_f32 v153, v153
    v_smfmac_f32_32x32x32_bf16 v[184:199], v[100:103], v[144:151], v9
    buffer_load_dwordx4 v[56:59], v3, s[28:31], s50 offen offset:2048 sc1
    v_exp_f32 v154, v154
    v_exp_f32 v155, v155
    v_exp_f32 v156, v156
    v_exp_f32 v157, v157
    v_exp_f32 v158, v158
    ds_read_b128 v[120:123], v10 offset:8192
    ds_read_b128 v[124:127], v10 offset:9216
    ds_read_b128 v[128:131], v10 offset:10240
    ds_read_b128 v[132:135], v10 offset:11264
    ds_read_b128 v[136:139], v10 offset:12288
    v_exp_f32 v159, v159
    v_exp_f32 v160, v160
    v_exp_f32 v161, v161
    v_exp_f32 v162, v162
    v_smfmac_f32_32x32x32_bf16 v[184:199], v[104:107], v[152:159], v9
    v_exp_f32 v163, v163
    v_exp_f32 v164, v164
    v_exp_f32 v165, v165
    s_waitcnt vmcnt(10)
    v_mfma_f32_16x16x32_bf16 v[208:211], v[24:27], v[244:247], v[208:211]
    v_exp_f32 v166, v166
    v_exp_f32 v167, v167
    s_waitcnt vmcnt(8)
    v_mfma_f32_16x16x32_bf16 v[212:215], v[28:31], v[244:247], v[212:215]
B_tail:
    v_smfmac_f32_32x32x32_bf16 v[184:199], v[108:111], v[160:167], v9
    s_waitcnt vmcnt(3)
    s_waitcnt lgkmcnt(0)
    v_lshlrev_b32 v152, 16, v248
    v_mfma_f32_16x16x32_bf16 v[200:203], v[216:219], v[232:235], v[200:203]
    v_and_b32 v153, 0xffff0000, v248
    v_lshlrev_b32 v154, 16, v249
    v_mfma_f32_16x16x32_bf16 v[204:207], v[220:223], v[232:235], v[204:207]
    v_and_b32 v155, 0xffff0000, v249
    v_lshlrev_b32 v156, 16, v250
    v_mfma_f32_16x16x32_bf16 v[208:211], v[224:227], v[232:235], v[208:211]
    v_and_b32 v157, 0xffff0000, v250
    v_lshlrev_b32 v158, 16, v251
    v_mfma_f32_16x16x32_bf16 v[212:215], v[228:231], v[232:235], v[212:215]
    v_and_b32 v159, 0xffff0000, v251
    ds_write_b64 v14, v[184:185] offset:17408
    ds_write_b64 v14, v[186:187] offset:21504
    ds_write_b64 v14, v[188:189] offset:25600
    ds_write_b64 v14, v[190:191] offset:29696
    ds_write_b32 v15, v192 offset:33792
    v_mfma_f32_16x16x32_bf16 v[200:203], v[120:123], v[236:239], v[200:203]
    v_mfma_f32_16x16x32_bf16 v[204:207], v[124:127], v[236:239], v[204:207]
    v_mfma_f32_16x16x32_bf16 v[208:211], v[128:131], v[236:239], v[208:211]
    v_mfma_f32_16x16x32_bf16 v[212:215], v[132:135], v[236:239], v[212:215]
    s_xor_b32 s50, s41, 61440
    buffer_load_dwordx4 v[60:63], v3, s[28:31], s50 offen offset:0 sc1
    buffer_load_dwordx4 v[64:67], v3, s[28:31], s50 offen offset:1024 sc1
    buffer_load_dwordx4 v[68:71], v3, s[28:31], s50 offen offset:2048 sc1
    buffer_load_dwordx4 v[72:75], v3, s[28:31], s50 offen offset:3072 sc1
    s_waitcnt lgkmcnt(0)
    s_barrier
    s_cmp_lt_u32 s32, 4
    s_cbranch_scc1 B_r3
    s_setprio 2
    ds_read_b128 v[232:235], v0 offset:33792
    ds_read_b128 v[236:239], v0 offset:34304
    ds_read_b128 v[184:187], v6 offset:17408
    ds_read_b128 v[188:191], v6 offset:18432
    ds_read_b128 v[192:195], v6 offset:19456
    ds_read_b128 v[196:199], v6 offset:20480
B_r3:
    s_mov_b32 s60, 0x3f803f80
    v_dot2_f32_bf16 v112, v252, s60, 0
    v_dot2_f32_bf16 v112, v253, s60, v112
    v_dot2_f32_bf16 v112, v254, s60, v112
    v_dot2_f32_bf16 v112, v255, s60, v112
    v_and_b32 v163, 7, v1
    v_lshlrev_b32 v162, 5, v163
    v_and_b32 v10, 48, v1
    v_lshl_add_u32 v162, v10, 4, v162
    s_lshl_b32 s45, s32, 2
    v_add_u32 v10, s45, v162
    s_lshr_b32 s50, s40, 10
    s_lshl_b32 s50, s50, 1
    s_sub_u32 s51, 0xfffe, s50
    v_lshlrev_b32 v163, 1, v163
    v_sub_u32 v163, s51, v163
    s_mov_b32 s61, 0xffff0000
    s_mov_b64 vcc, 0
    s_cmp_lt_u32 s32, 4
    s_cbranch_scc1 B_r4
    s_waitcnt lgkmcnt(0)
    v_pk_add_f32 v[232:233], v[232:233], v[234:235]
    v_pk_add_f32 v[236:237], v[236:237], v[238:239]
    v_pk_add_f32 v[184:185], v[184:185], v[186:187]
    v_pk_add_f32 v[188:189], v[188:189], v[190:191]
    v_pk_add_f32 v[192:193], v[192:193], v[194:195]
    v_pk_add_f32 v[196:197], v[196:197], v[198:199]
    v_pk_add_f32 v[232:233], v[232:233], v[236:237]
    v_pk_add_f32 v[184:185], v[184:185], v[188:189]
    v_add_f32 v232, v232, v233
    v_pk_add_f32 v[192:193], v[192:193], v[196:197]
    v_rcp_f32 v234, v232
    v_pk_add_f32 v[184:185], v[184:185], v[192:193]
    v_maximum3_f32 v233, |v184|, |v185|, |v185|
    v_pk_mul_f32 v[184:185], v[184:185], v[234:235] op_sel_hi:[1,0]
    v_maximum3_f32 v12, v12, v232, v233
    v_cvt_pk_bf16_f32 v184, v184, v185
    v_min_f32 v13, v13, v233
    ds_write_b32 v5, v184 offset:39936
    v_mul_f32 v12, 0x43800000, v12
    v_fma_f32 v13, v12, 0, v13
    v_cmp_nle_f32 vcc, 0xb000000, v13
    s_waitcnt lgkmcnt(0)
B_r4:
    s_barrier
    ds_read_b128 v[240:243], v7 offset:39936
    ds_read_b128 v[244:247], v7 offset:40448
    s_setprio 0
    v_and_b32 v160, 8, v1
    v_lshlrev_b32 v160, 3, v160
    v_and_b32 v161, 48, v1
    v_add_u32 v160, v160, v161
    v_and_b32 v161, 7, v1
    v_lshl_add_u32 v161, v161, 10, v160
    s_waitcnt vmcnt(4) lgkmcnt(1)
    v_mfma_f32_16x16x32_bf16 v[200:203], v[136:139], v[240:243], v[200:203]
    v_mfma_f32_16x16x32_bf16 v[204:207], v[48:51], v[240:243], v[204:207]
    v_mfma_f32_16x16x32_bf16 v[208:211], v[52:55], v[240:243], v[208:211]
    v_mfma_f32_16x16x32_bf16 v[212:215], v[56:59], v[240:243], v[212:215]
    s_waitcnt vmcnt(0) lgkmcnt(0)
    v_mfma_f32_16x16x32_bf16 v[200:203], v[60:63], v[244:247], v[200:203]
    v_mfma_f32_16x16x32_bf16 v[204:207], v[64:67], v[244:247], v[204:207]
    v_mfma_f32_16x16x32_bf16 v[208:211], v[68:71], v[244:247], v[208:211]
    v_mfma_f32_16x16x32_bf16 v[212:215], v[72:75], v[244:247], v[212:215]
    s_mov_b64 exec, vcc
    ds_write_b32 v2, v9
    s_mov_b64 exec, -1
    s_nop 4
    v_cvt_pk_bf16_f32 v220, v208, v212
    v_cvt_pk_bf16_f32 v221, v209, v213
    v_cvt_pk_bf16_f32 v222, v210, v214
    v_cvt_pk_bf16_f32 v223, v211, v215
    v_cvt_pk_bf16_f32 v216, v200, v204
    v_cvt_pk_bf16_f32 v217, v201, v205
    v_cvt_pk_bf16_f32 v218, v202, v206
    v_cvt_pk_bf16_f32 v219, v203, v207
    v_mov_b32_dpp v216, v220 row_ror:8 row_mask:0xf bank_mask:0xc
    v_mov_b32_dpp v217, v221 row_ror:8 row_mask:0xf bank_mask:0xc
    v_mov_b32_dpp v218, v222 row_ror:8 row_mask:0xf bank_mask:0xc
    v_mov_b32_dpp v219, v223 row_ror:8 row_mask:0xf bank_mask:0xc
    v_lshlrev_b32 v136, 16, v216
    v_and_b32 v137, 0xffff0000, v216
    v_lshlrev_b32 v138, 16, v217
    v_and_b32 v139, 0xffff0000, v217
    v_lshlrev_b32 v140, 16, v218
    v_and_b32 v141, 0xffff0000, v218
    v_lshlrev_b32 v142, 16, v219
    v_and_b32 v143, 0xffff0000, v219
    v_pk_add_f32 v[136:137], v[136:137], v[152:153]
    v_pk_add_f32 v[138:139], v[138:139], v[154:155]
    v_pk_add_f32 v[140:141], v[140:141], v[156:157]
    v_pk_add_f32 v[142:143], v[142:143], v[158:159]
    v_cvt_pk_bf16_f32 v168, v136, v137
    v_cvt_pk_bf16_f32 v169, v138, v139
    v_cvt_pk_bf16_f32 v170, v140, v141
    v_cvt_pk_bf16_f32 v171, v142, v143
    v_dot2_f32_bf16 v178, v168, v252, 0
    v_dot2_f32_bf16 v176, v168, s60, 0
    v_dot2_f32_bf16 v177, v168, v168, 0
    v_dot2_f32_bf16 v178, v169, v253, v178
    v_dot2_f32_bf16 v176, v169, s60, v176
    v_dot2_f32_bf16 v177, v169, v169, v177
    v_dot2_f32_bf16 v178, v170, v254, v178
    v_dot2_f32_bf16 v176, v170, s60, v176
    v_dot2_f32_bf16 v177, v170, v170, v177
    v_dot2_f32_bf16 v178, v171, v255, v178
    v_dot2_f32_bf16 v176, v171, s60, v176
    v_dot2_f32_bf16 v177, v171, v171, v177
    v_lshlrev_b32 v120, 16, v168
    v_and_b32 v121, 0xffff0000, v168
    v_permlane32_swap_b32 v178, v112
    v_permlane32_swap_b32 v176, v177
    v_add_f32 v178, v178, v112
    v_add_f32 v176, v176, v177
    v_lshlrev_b32 v122, 16, v169
    v_and_b32 v123, 0xffff0000, v169
    v_permlane16_swap_b32 v176, v178
    v_add_f32 v176, v176, v178
    v_lshlrev_b32 v124, 16, v170
    v_and_b32 v125, 0xffff0000, v170
    v_add_f32_dpp v176, v176, v176 row_ror:8 row_mask:0xf bank_mask:0xf
    ds_write_b32 v10, v176 offset:0
    v_lshlrev_b32 v126, 16, v171
    v_and_b32 v127, 0xffff0000, v171
    s_cmp_lg_u32 s32, 0
    s_cbranch_scc1 B_e1
    s_setprio 3
B_e1:
    s_waitcnt lgkmcnt(0)
    s_barrier
    ds_read_b128 v[216:219], v162 offset:0
    ds_read_b128 v[220:223], v162 offset:16
    ds_read_b32 v224, v2
    s_lshl_b32 s50, s8, 7
    s_add_u32 s50, s50, 0x500000
    v_lshrrev_b32 v228, 3, v1
    v_lshlrev_b32 v228, 15, v228
    v_and_b32 v229, 7, v1
    v_lshl_add_u32 v228, v229, 4, v228
    s_waitcnt lgkmcnt(0)
    v_pk_add_f32 v[216:217], v[216:217], v[218:219]
    v_pk_add_f32 v[220:221], v[220:221], v[222:223]
    v_readfirstlane_b32 s45, v224
    v_pk_add_f32 v[216:217], v[216:217], v[220:221]
    v_add_f32 v216, v216, v217
    v_mov_b32 v218, v216
    s_cmp_gt_u32 s45, s33
    s_cbranch_scc1 B_redo
    v_permlane32_swap_b32 v216, v218
    v_mov_b32 v217, v216
    v_mov_b32 v219, v218
    s_nop 0
    v_permlane16_swap_b32 v216, v217
    v_permlane16_swap_b32 v218, v219
    v_mul_f32 v68, 0x3b000000, v216
    v_mul_f32 v72, 0x3b000000, v218
    v_fma_f32 v72, -v68, v68, v72
    v_max_f32 v72, 0, v72
    v_cvt_pk_bf16_f32 v72, v68, v72
    v_lshlrev_b32 v70, 16, v72
    v_and_b32 v72, 0xffff0000, v72
    v_add_f32 v72, 0x3727c5ac, v72
    v_cvt_pk_bf16_f32 v72, v72, v72
    v_and_b32 v72, 0xffff0000, v72
    v_sqrt_f32 v72, v72
    v_fma_f32 v74, -v70, v219, v217
    v_cvt_pk_bf16_f32 v72, v72, v72
    v_and_b32 v72, 0xffff0000, v72
    v_rcp_f32 v72, v72
    s_nop 0
    v_mul_f32 v74, v74, v72
    v_cvt_pk_bf16_f32 v74, v74, v74
    v_ashrrev_i32 v68, 31, v74
    v_or_b32 v68, 0x80000000, v68
    v_xor_b32 v74, v74, v68
    v_and_or_b32 v74, v74, s61, v163
    v_pk_add_f32 v[128:129], v[120:121], v[70:71] op_sel_hi:[1,0] neg_lo:[0,1] neg_hi:[0,1]
    v_pk_add_f32 v[130:131], v[122:123], v[70:71] op_sel_hi:[1,0] neg_lo:[0,1] neg_hi:[0,1]
    v_max_u32_dpp v76, v74, v74 quad_perm:[1,0,3,2] row_mask:0xf bank_mask:0xf
    v_pk_add_f32 v[132:133], v[124:125], v[70:71] op_sel_hi:[1,0] neg_lo:[0,1] neg_hi:[0,1]
    v_pk_add_f32 v[134:135], v[126:127], v[70:71] op_sel_hi:[1,0] neg_lo:[0,1] neg_hi:[0,1]
    v_max_u32_dpp v76, v76, v76 quad_perm:[2,3,0,1] row_mask:0xf bank_mask:0xf
    v_cvt_pk_bf16_f32 v172, v128, v129
    v_cvt_pk_bf16_f32 v173, v130, v131
    v_max_u32_dpp v76, v76, v76 row_half_mirror row_mask:0xf bank_mask:0xf
    v_cmp_lt_u32 vcc, v74, v76
    v_cvt_pk_bf16_f32 v174, v132, v133
    v_cvt_pk_bf16_f32 v175, v134, v135
    v_cndmask_b32 v77, 0, v74, vcc
    v_lshlrev_b32 v128, 16, v172
    v_and_b32 v129, 0xffff0000, v172
    v_max_u32_dpp v77, v77, v77 quad_perm:[1,0,3,2] row_mask:0xf bank_mask:0xf
    v_lshlrev_b32 v130, 16, v173
    v_and_b32 v131, 0xffff0000, v173
    v_max_u32_dpp v77, v77, v77 quad_perm:[2,3,0,1] row_mask:0xf bank_mask:0xf
    v_lshlrev_b32 v132, 16, v174
    v_and_b32 v133, 0xffff0000, v174
    v_max_u32_dpp v77, v77, v77 row_half_mirror row_mask:0xf bank_mask:0xf
    v_cmp_ge_u32 s[62:63], v74, v77
    v_or_b32 v77, 1, v77
    s_cmp_lg_u32 s32, 0
    s_cbranch_scc1 B_nk
    s_mov_b64 exec, 0xffff
    buffer_store_dwordx4 v[76:79], v228, s[28:31], s50 offen sc1
    s_mov_b64 exec, -1
    s_setprio 0
B_nk:
    v_lshlrev_b32 v134, 16, v175
    v_and_b32 v135, 0xffff0000, v175
    v_pk_mul_f32 v[128:129], v[128:129], v[72:73] op_sel_hi:[1,0]
    v_pk_mul_f32 v[130:131], v[130:131], v[72:73] op_sel_hi:[1,0]
    v_pk_mul_f32 v[132:133], v[132:133], v[72:73] op_sel_hi:[1,0]
    v_pk_mul_f32 v[134:135], v[134:135], v[72:73] op_sel_hi:[1,0]
    v_cvt_pk_bf16_f32 v172, v128, v129
    v_cvt_pk_bf16_f32 v173, v130, v131
    v_cvt_pk_bf16_f32 v174, v132, v133
    v_cvt_pk_bf16_f32 v175, v134, v135
    v_add_u32 v68, 1024, v160
    v_cndmask_b32 v160, v160, v68, vcc
    v_min_u32 v216, 0xfffeffff, v172
    v_min_u32 v217, 0xfffeffff, v173
    v_min_u32 v218, 0xfffeffff, v174
    v_min_u32 v219, 0xfffeffff, v175
    s_lshl_b32 s46, s8, 11
    s_add_u32 s46, s46, s10
    s_add_u32 s47, s46, 0x400000
    s_add_u32 s46, s46, 0x480000
    s_mov_b64 exec, s[62:63]
    buffer_store_dwordx4 v[216:219], v160, s[28:31], s47 offen sc1
    buffer_store_dwordx4 v[168:171], v160, s[28:31], s46 offen sc1
    s_mov_b64 exec, -1
    v_lshlrev_b32 v128, 16, v172
    v_and_b32 v129, 0xffff0000, v172
    v_lshlrev_b32 v130, 16, v173
    v_and_b32 v131, 0xffff0000, v173
    v_lshlrev_b32 v132, 16, v174
    v_and_b32 v133, 0xffff0000, v174
    v_lshlrev_b32 v134, 16, v175
    v_and_b32 v135, 0xffff0000, v175
    v_pk_add_f32 v[120:121], v[120:121], v[128:129]
    v_pk_add_f32 v[122:123], v[122:123], v[130:131]
    v_pk_add_f32 v[124:125], v[124:125], v[132:133]
    v_pk_add_f32 v[126:127], v[126:127], v[134:135]
    v_cvt_pk_bf16_f32 v200, v120, v121
    v_cvt_pk_bf16_f32 v201, v122, v123
    v_cvt_pk_bf16_f32 v202, v124, v125
    v_cvt_pk_bf16_f32 v203, v126, v127
    s_mov_b64 exec, s[62:63]
    buffer_store_dwordx4 v[200:203], v161, s[24:27], s40 offen sc1
    s_not_b64 exec, exec
    buffer_store_dwordx4 v[200:203], v161, s[24:27], s40 offen
    s_mov_b64 exec, -1
    s_lshl2_add_u32 s50, s32, s50
    s_add_u32 s50, s50, 0x40000
    v_mov_b32 v204, s3
    s_mov_b32 s45, s32
    s_cmp_lg_u32 s32, 7
    s_cbranch_scc1 B_k2
    s_cmp_lg_u32 s54, 0
    s_cbranch_scc1 B_pub
B_k2:
    s_waitcnt vmcnt(0)
    s_mov_b64 exec, 1
    buffer_store_dword v204, off, s[28:31], s50 sc1
    s_mov_b64 exec, -1
B_pub:
    s_cmp_lg_u32 s54, 0
    s_cbranch_scc1 B_ffn
B_fin:
B_done:
    s_endpgm
B_ffn:
    s_mov_b32 s35, s45
    s_cmp_eq_u32 s54, 2
    s_cbranch_scc0 B_nst
    s_add_u32 m0, s42, 8192
    s_add_u32 s46, s53, 131072
    buffer_load_dwordx4 v8, s[56:59], s46 offen lds
    s_add_u32 m0, s42, 9216
    s_add_u32 s46, s53, 147456
    buffer_load_dwordx4 v8, s[56:59], s46 offen lds
    s_add_u32 m0, s42, 10240
    s_add_u32 s46, s53, 163840
    buffer_load_dwordx4 v8, s[56:59], s46 offen lds
    s_add_u32 m0, s42, 11264
    s_add_u32 s46, s53, 180224
    buffer_load_dwordx4 v8, s[56:59], s46 offen lds
B_nst:
    v_lshrrev_b32 v6, 4, v1
    v_bfe_u32 v10, v1, 2, 2
    v_lshl_add_u32 v10, v6, 3, v10
    v_lshlrev_b32 v10, 6, v10
    v_and_b32 v11, 3, v1
    v_lshl_add_u32 v10, v11, 3, v10
    v_add_u32 v10, s42, v10
    s_lshl_b32 s45, s32, 8
    s_add_u32 s45, s45, 155904
    v_and_b32 v11, 1, v1
    v_lshlrev_b32 v5, 7, v11
    v_lshl_add_u32 v5, v6, 4, v5
    v_add_u32 v5, s45, v5
    s_cmp_eq_u32 s54, 2
    s_cselect_b32 s45, 64, 1088
    v_mul_lo_u32 v7, s45, v11
    v_lshl_add_u32 v7, v6, 4, v7
    s_lshr_b32 s45, s32, 1
    s_lshl_b32 s45, s45, 8
    s_add_u32 s45, s45, 17408
    s_add_u32 s46, s48, 20480
    s_cmp_eq_u32 s54, 2
    s_cselect_b32 s45, s46, s45
    v_add_u32 v7, s45, v7
    ds_read_b64_tr_b16 v[16:17], v10 offset:0
    ds_read_b64_tr_b16 v[18:19], v10 offset:256
    ds_read_b64_tr_b16 v[20:21], v10 offset:32
    ds_read_b64_tr_b16 v[22:23], v10 offset:288
    ds_read_b64_tr_b16 v[24:25], v10 offset:2048
    ds_read_b64_tr_b16 v[26:27], v10 offset:2304
    ds_read_b64_tr_b16 v[28:29], v10 offset:2080
    ds_read_b64_tr_b16 v[30:31], v10 offset:2336
    ds_read_b64_tr_b16 v[32:33], v10 offset:4096
    ds_read_b64_tr_b16 v[34:35], v10 offset:4352
    ds_read_b64_tr_b16 v[36:37], v10 offset:4128
    ds_read_b64_tr_b16 v[38:39], v10 offset:4384
    ds_read_b64_tr_b16 v[40:41], v10 offset:6144
    ds_read_b64_tr_b16 v[42:43], v10 offset:6400
    ds_read_b64_tr_b16 v[44:45], v10 offset:6176
    ds_read_b64_tr_b16 v[46:47], v10 offset:6432
    s_cmp_lg_u32 s35, 7
    s_cbranch_scc1 B_pw
    v_lshlrev_b32 v71, 9, v1
    s_and_b32 s45, s2, 1
    s_lshl_b32 s45, s45, 15
    s_add_u32 s45, s45, 0x500000
    s_mov_b32 s46, 1048576
    buffer_load_dwordx2 v[80:81], v71, s[28:31], s45 offen offset:0 sc1
    buffer_load_dwordx2 v[82:83], v71, s[28:31], s45 offen offset:128 sc1
    buffer_load_dwordx2 v[84:85], v71, s[28:31], s45 offen offset:256 sc1
    buffer_load_dwordx2 v[86:87], v71, s[28:31], s45 offen offset:384 sc1
    s_waitcnt vmcnt(4)
    s_mov_b64 exec, 1
    buffer_store_dword v204, off, s[28:31], s50 sc1
    s_mov_b64 exec, -1
B_pk:
    buffer_load_dwordx2 v[88:89], v71, s[28:31], s45 offen offset:0 sc1
    buffer_load_dwordx2 v[90:91], v71, s[28:31], s45 offen offset:128 sc1
    buffer_load_dwordx2 v[92:93], v71, s[28:31], s45 offen offset:256 sc1
    buffer_load_dwordx2 v[94:95], v71, s[28:31], s45 offen offset:384 sc1
    s_waitcnt vmcnt(4)
    v_min3_u32 v11, v80, v81, v82
    v_min3_u32 v64, v83, v84, v85
    v_min3_u32 v11, v11, v86, v87
    v_min_u32 v11, v11, v64
    v_cmp_ne_u32 vcc, 0, v11
    s_cmp_eq_u64 vcc, -1
    s_cbranch_scc1 B_pk1
    buffer_load_dwordx2 v[80:81], v71, s[28:31], s45 offen offset:0 sc1
    buffer_load_dwordx2 v[82:83], v71, s[28:31], s45 offen offset:128 sc1
    buffer_load_dwordx2 v[84:85], v71, s[28:31], s45 offen offset:256 sc1
    buffer_load_dwordx2 v[86:87], v71, s[28:31], s45 offen offset:384 sc1
    s_waitcnt vmcnt(4)
    v_min3_u32 v11, v88, v89, v90
    v_min3_u32 v64, v91, v92, v93
    v_min3_u32 v11, v11, v94, v95
    v_min_u32 v11, v11, v64
    v_cmp_ne_u32 vcc, 0, v11
    s_cmp_eq_u64 vcc, -1
    s_cbranch_scc1 B_pk2
    s_sub_u32 s46, s46, 1
    s_cbranch_scc0 B_pk
B_pk2:
    v_min_u32 v70, v88, v90
    v_max_u32 v64, v88, v90
    v_max3_u32 v65, v89, v91, v70
    v_min_u32 v70, v92, v94
    v_max_u32 v66, v92, v94
    v_max3_u32 v67, v93, v95, v70
    s_branch B_pkd
B_pk1:
    v_min_u32 v70, v80, v82
    v_max_u32 v64, v80, v82
    v_max3_u32 v65, v81, v83, v70
    v_min_u32 v70, v84, v86
    v_max_u32 v66, v84, v86
    v_max3_u32 v67, v85, v87, v70
B_pkd:
    v_min_u32 v70, v64, v66
    v_max_u32 v68, v64, v66
    v_max3_u32 v69, v65, v67, v70
    s_nop 0
    v_min_u32_dpp v70, v68, v68 row_ror:8 row_mask:0xf bank_mask:0xf
    v_max_u32_dpp v68, v68, v68 row_ror:8 row_mask:0xf bank_mask:0xf
    v_max_u32_dpp v69, v69, v69 row_ror:8 row_mask:0xf bank_mask:0xf
    v_max_u32 v69, v69, v70
    v_min_u32_dpp v70, v68, v68 row_ror:4 row_mask:0xf bank_mask:0xf
    v_max_u32_dpp v68, v68, v68 row_ror:4 row_mask:0xf bank_mask:0xf
    v_max_u32_dpp v69, v69, v69 row_ror:4 row_mask:0xf bank_mask:0xf
    v_max_u32 v69, v69, v70
    v_min_u32_dpp v70, v68, v68 row_ror:2 row_mask:0xf bank_mask:0xf
    v_max_u32_dpp v68, v68, v68 row_ror:2 row_mask:0xf bank_mask:0xf
    v_max_u32_dpp v69, v69, v69 row_ror:2 row_mask:0xf bank_mask:0xf
    v_max_u32 v69, v69, v70
    v_min_u32_dpp v70, v68, v68 row_ror:1 row_mask:0xf bank_mask:0xf
    v_max_u32_dpp v68, v68, v68 row_ror:1 row_mask:0xf bank_mask:0xf
    v_max_u32_dpp v69, v69, v69 row_ror:1 row_mask:0xf bank_mask:0xf
    v_max_u32 v69, v69, v70
    v_min_u32_dpp v70, v68, v68 row_bcast:15 row_mask:0xa bank_mask:0xf
    v_max_u32_dpp v68, v68, v68 row_bcast:15 row_mask:0xa bank_mask:0xf
    v_max_u32_dpp v69, v69, v69 row_bcast:15 row_mask:0xa bank_mask:0xf
    v_max_u32 v69, v69, v70
    v_min_u32_dpp v70, v68, v68 row_bcast:31 row_mask:0xc bank_mask:0xf
    v_max_u32_dpp v68, v68, v68 row_bcast:31 row_mask:0xc bank_mask:0xf
    v_max_u32_dpp v69, v69, v69 row_bcast:31 row_mask:0xc bank_mask:0xf
    v_max_u32 v69, v69, v70
    v_readlane_b32 s60, v68, 63
    v_readlane_b32 s61, v69, 63
    s_bfe_u32 s45, s60, 0x80004
    s_sub_u32 s45, 255, s45
    s_bfe_u32 s46, s45, 0x30002
    s_and_b32 s47, s45, 3
    s_lshl3_add_u32 s46, s47, s46
    s_and_b32 s45, s45, 0xe0
    s_add_u32 s45, s45, s46
    s_and_b32 s46, s60, 1
    s_lshl1_add_u32 s62, s45, s46
    s_bfe_u32 s45, s61, 0x80004
    s_sub_u32 s45, 255, s45
    s_bfe_u32 s46, s45, 0x30002
    s_and_b32 s47, s45, 3
    s_lshl3_add_u32 s46, s47, s46
    s_and_b32 s45, s45, 0xe0
    s_add_u32 s45, s45, s46
    s_and_b32 s46, s61, 1
    s_lshl1_add_u32 s63, s45, s46
    s_cmp_eq_u32 s54, 2
    s_cbranch_scc1 B_dsel
    s_lshl_b32 s62, s62, 10
    s_lshl_b32 s63, s63, 10
    s_add_u32 s62, s62, 0x400000
    s_add_u32 s63, s63, 0x400000
    s_mov_b32 s46, 1048576
B_px:
    buffer_load_dwordx4 v[104:107], v3, s[28:31], s62 offen sc1
    buffer_load_dwordx4 v[108:111], v3, s[28:31], s63 offen sc1
B_px1:
    s_waitcnt vmcnt(0)
    ds_write_b128 v3, v[104:107] offset:17408
    ds_write_b128 v3, v[108:111] offset:18496
    v_max3_u32 v11, v104, v105, v106
    v_max3_u32 v70, v107, v108, v109
    v_max3_u32 v11, v11, v110, v111
    v_max_u32 v11, v11, v70
    v_cmp_ne_u32 vcc, -1, v11
    s_sub_u32 s46, s46, 1
    s_cbranch_scc1 B_pw
    s_cmp_eq_u64 vcc, -1
    s_cbranch_scc0 B_px
B_pw:
    s_waitcnt lgkmcnt(0)
    s_barrier
    s_cmp_eq_u32 s54, 2
    s_cbranch_scc1 B_down
    ds_read_b128 v[80:83], v7 offset:0
    ds_read_b128 v[84:87], v7 offset:64
    ds_read_b128 v[88:91], v7 offset:128
    ds_read_b128 v[92:95], v7 offset:192
    s_waitcnt lgkmcnt(3)
    v_mfma_f32_16x16x32_bf16 v[104:107], v[16:19], v[80:83], 0
    v_mfma_f32_16x16x32_bf16 v[108:111], v[20:23], v[80:83], 0
    s_waitcnt lgkmcnt(2)
    v_mfma_f32_16x16x32_bf16 v[104:107], v[24:27], v[84:87], v[104:107]
    v_mfma_f32_16x16x32_bf16 v[108:111], v[28:31], v[84:87], v[108:111]
    s_waitcnt lgkmcnt(1)
    v_mfma_f32_16x16x32_bf16 v[104:107], v[32:35], v[88:91], v[104:107]
    v_mfma_f32_16x16x32_bf16 v[108:111], v[36:39], v[88:91], v[108:111]
    s_waitcnt lgkmcnt(0)
    v_mfma_f32_16x16x32_bf16 v[104:107], v[40:43], v[92:95], v[104:107]
    v_mfma_f32_16x16x32_bf16 v[108:111], v[44:47], v[92:95], v[108:111]
    s_mov_b32 exec_lo, 0x00030003
    s_mov_b32 exec_hi, 0x00030003
    s_nop 4
    ds_write_b128 v5, v[104:107]
    ds_write_b128 v5, v[108:111] offset:64
    s_mov_b64 exec, -1
    v_lshl_add_u32 v10, v1, 2, v2
    s_waitcnt lgkmcnt(0)
    s_barrier
    s_cmp_lg_u32 s35, 7
    s_cbranch_scc1 B_fo
    ds_read2st64_b32 v[16:17], v10 offset0:1 offset1:2
    ds_read2st64_b32 v[18:19], v10 offset0:3 offset1:4
    ds_read2st64_b32 v[20:21], v10 offset0:5 offset1:6
    ds_read2st64_b32 v[22:23], v10 offset0:7 offset1:8
    v_lshlrev_b32 v11, 1, v1
    s_lshl_b32 s45, s55, 7
    s_add_u32 s45, s45, 0x548000
    s_waitcnt lgkmcnt(0)
    v_pk_add_f32 v[16:17], v[16:17], v[18:19]
    v_pk_add_f32 v[20:21], v[20:21], v[22:23]
    v_pk_add_f32 v[16:17], v[16:17], v[20:21]
    v_cvt_pk_bf16_f32 v17, v16, v17
    v_lshlrev_b32 v16, 16, v17
    v_and_b32 v17, 0xffff0000, v17
    v_mul_f32 v18, 0xbfb8aa3b, v16
    v_exp_f32 v18, v18
    s_nop 0
    v_add_f32 v18, 1.0, v18
    v_rcp_f32 v18, v18
    s_nop 0
    v_mul_f32 v16, v16, v18
    v_cvt_pk_bf16_f32 v16, v16, v16
    v_and_b32 v16, 0xffff0000, v16
    v_mul_f32 v16, v16, v17
    s_nop 1
    v_mov_b32_dpp v17, v16 quad_perm:[1,1,3,3] row_mask:0xf bank_mask:0xf
    v_cvt_pk_bf16_f32 v16, v16, v17
    v_min_u32 v16, 0xfffeffff, v16
    s_mov_b32 exec_lo, 0x55555555
    s_mov_b32 exec_hi, 0x55555555
    buffer_store_dword v16, v11, s[28:31], s45 offen sc1
    s_add_u32 s45, s45, 8192
    buffer_store_dword v16, v11, s[28:31], s45 offen sc1
    s_add_u32 s45, s45, 8192
    buffer_store_dword v16, v11, s[28:31], s45 offen sc1
    s_add_u32 s45, s45, 8192
    buffer_store_dword v16, v11, s[28:31], s45 offen sc1
    s_branch B_fin
B_dsel:
    s_barrier
    v_cmp_gt_u32 vcc, 32, v1
    v_mov_b32 v74, s61
    v_mov_b32 v11, s60
    v_mov_b32 v72, s63
    v_mov_b32 v73, s62
    v_cndmask_b32 v74, v74, v11, vcc
    v_cndmask_b32 v72, v72, v73, vcc
    v_lshrrev_b32 v71, 1, v72
    v_lshlrev_b32 v71, 7, v71
    s_lshr_b32 s45, s55, 1
    s_lshl_b32 s45, s45, 2
    s_add_u32 s45, s45, 0x540000
    s_mov_b32 s46, 1048576
B_p2:
    buffer_load_dword v70, v71, s[28:31], s45 offen sc1
    s_waitcnt vmcnt(0)
    v_cmp_eq_u32 vcc, s3, v70
    s_sub_u32 s46, s46, 1
    s_cbranch_scc1 B_p2d
    s_cmp_eq_u64 vcc, -1
    s_cbranch_scc0 B_p2
B_p2d:
    v_and_b32 v11, 31, v1
    v_lshlrev_b32 v11, 1, v11
    v_lshl_add_u32 v71, v72, 10, v11
    s_lshl_b32 s51, s55, 6
    s_add_u32 s45, s51, 0x480000
    s_add_u32 s46, s51, 0x400000
    buffer_load_ushort v72, v71, s[28:31], s45 offen sc1
    buffer_load_ushort v73, v71, s[28:31], s46 offen sc1
    v_not_b32 v75, v74
    v_bfe_u32 v75, v75, 1, 11
    v_lshl_add_u32 v75, v75, 10, v11
    v_and_b32 v74, 0xffff0000, v74
    v_ashrrev_i32 v11, 31, v74
    v_not_b32 v11, v11
    v_or_b32 v11, 0x80000000, v11
    v_xor_b32 v74, v74, v11
    v_and_b32 v74, 0xffff0000, v74
    v_mul_f32 v74, 0xbfb8aa3b, v74
    v_exp_f32 v74, v74
    s_nop 0
    v_add_f32 v74, 1.0, v74
    v_rcp_f32 v74, v74
    s_nop 0
    v_cvt_pk_bf16_f32 v74, v74, v74
    v_and_b32 v74, 0xffff0000, v74
B_down:
    s_waitcnt vmcnt(0)
    ds_read_b64_tr_b16 v[48:49], v10 offset:8192
    ds_read_b64_tr_b16 v[50:51], v10 offset:8448
    ds_read_b64_tr_b16 v[52:53], v10 offset:8224
    ds_read_b64_tr_b16 v[54:55], v10 offset:8480
    ds_read_b64_tr_b16 v[56:57], v10 offset:10240
    ds_read_b64_tr_b16 v[58:59], v10 offset:10496
    ds_read_b64_tr_b16 v[60:61], v10 offset:10272
    ds_read_b64_tr_b16 v[62:63], v10 offset:10528
    s_cmp_eq_u32 s32, 7
    s_cselect_b32 s45, 8, 48
    v_cmp_gt_u32 vcc, s45, v1
    v_mov_b32 v11, 0x40000000
    s_nop 0
    v_cndmask_b32 v11, v11, v3, vcc
    v_add_u32 v10, s48, v3
    s_mul_i32 s45, s32, 768
    s_and_b32 s46, s2, 3
    s_lshl_b32 s46, s46, 13
    s_add_u32 s45, s45, s46
    s_add_u32 s45, s45, 0x548000
    s_mov_b32 s46, 1048576
    buffer_load_dwordx4 v[76:79], v11, s[28:31], s45 offen sc1
B_pa:
    buffer_load_dwordx4 v[64:67], v11, s[28:31], s45 offen sc1
    s_waitcnt vmcnt(1)
    ds_write_b128 v10, v[76:79] offset:20480
    v_max3_u32 v70, v76, v77, v78
    v_max_u32 v70, v70, v79
    v_cmp_ne_u32 vcc, -1, v70
    s_cmp_eq_u64 vcc, -1
    s_cbranch_scc1 B_pad
    buffer_load_dwordx4 v[76:79], v11, s[28:31], s45 offen sc1
    s_waitcnt vmcnt(1)
    ds_write_b128 v10, v[64:67] offset:20480
    v_max3_u32 v70, v64, v65, v66
    v_max_u32 v70, v70, v67
    v_cmp_ne_u32 vcc, -1, v70
    s_cmp_eq_u64 vcc, -1
    s_cbranch_scc1 B_pad
    s_sub_u32 s46, s46, 1
    s_cbranch_scc0 B_pa
B_pad:
    ds_read_b128 v[80:83], v7 offset:0
    ds_read_b128 v[84:87], v7 offset:128
    ds_read_b128 v[88:91], v7 offset:256
    ds_read_b128 v[92:95], v7 offset:384
    ds_read_b128 v[96:99], v7 offset:512
    ds_read_b128 v[100:103], v7 offset:640
    s_waitcnt lgkmcnt(5)
    v_mfma_f32_16x16x32_bf16 v[104:107], v[16:19], v[80:83], 0
    v_mfma_f32_16x16x32_bf16 v[108:111], v[20:23], v[80:83], 0
    s_waitcnt lgkmcnt(4)
    v_mfma_f32_16x16x32_bf16 v[104:107], v[24:27], v[84:87], v[104:107]
    v_mfma_f32_16x16x32_bf16 v[108:111], v[28:31], v[84:87], v[108:111]
    s_waitcnt lgkmcnt(3)
    v_mfma_f32_16x16x32_bf16 v[104:107], v[32:35], v[88:91], v[104:107]
    v_mfma_f32_16x16x32_bf16 v[108:111], v[36:39], v[88:91], v[108:111]
    s_waitcnt lgkmcnt(2)
    v_mfma_f32_16x16x32_bf16 v[104:107], v[40:43], v[92:95], v[104:107]
    v_mfma_f32_16x16x32_bf16 v[108:111], v[44:47], v[92:95], v[108:111]
    s_waitcnt lgkmcnt(1)
    v_mfma_f32_16x16x32_bf16 v[104:107], v[48:51], v[96:99], v[104:107]
    v_mfma_f32_16x16x32_bf16 v[108:111], v[52:55], v[96:99], v[108:111]
    s_waitcnt lgkmcnt(0)
    v_mfma_f32_16x16x32_bf16 v[104:107], v[56:59], v[100:103], v[104:107]
    v_mfma_f32_16x16x32_bf16 v[108:111], v[60:63], v[100:103], v[108:111]
    s_mov_b32 exec_lo, 0x00030003
    s_mov_b32 exec_hi, 0x00030003
    s_nop 4
    ds_write_b128 v5, v[104:107]
    ds_write_b128 v5, v[108:111] offset:64
    s_mov_b64 exec, -1
    v_lshl_add_u32 v10, v1, 2, v2
    s_waitcnt lgkmcnt(0)
    s_barrier
    s_cmp_lg_u32 s35, 7
    s_cbranch_scc1 B_fo
    ds_read2st64_b32 v[16:17], v10 offset0:1 offset1:2
    ds_read2st64_b32 v[18:19], v10 offset0:3 offset1:4
    ds_read2st64_b32 v[20:21], v10 offset0:5 offset1:6
    ds_read2st64_b32 v[22:23], v10 offset0:7 offset1:8
    v_lshlrev_b32 v72, 16, v72
    v_lshlrev_b32 v73, 16, v73
    s_waitcnt lgkmcnt(0)
    v_pk_add_f32 v[16:17], v[16:17], v[18:19]
    v_pk_add_f32 v[20:21], v[20:21], v[22:23]
    v_pk_add_f32 v[16:17], v[16:17], v[20:21]
    v_add_f32 v16, v16, v17
    v_cvt_pk_bf16_f32 v16, v16, v16
    v_and_b32 v16, 0xffff0000, v16
    v_mul_f32 v16, v16, v74
    v_cvt_pk_bf16_f32 v16, v16, v16
    v_and_b32 v16, 0xffff0000, v16
    v_add_f32 v16, v16, v73
    v_cvt_pk_bf16_f32 v16, v16, v16
    v_and_b32 v16, 0xffff0000, v16
    v_add_f32 v16, v16, v72
    v_cvt_pk_bf16_f32 v16, v16, v16
    buffer_store_short v16, v75, s[24:27], s51 offen
    s_branch B_fin
B_fo:
    s_branch B_fin
B_qw:
    s_mov_b32 s46, 1048576
B_qw1:
    buffer_load_dword v240, v241, s[28:31], 0 offen sc1
    s_waitcnt vmcnt(0)
    v_cmp_eq_u32 vcc, s3, v240
    s_cmp_eq_u64 vcc, -1
    s_cbranch_scc1 B_qr
    s_sub_u32 s46, s46, 1
    s_cbranch_scc0 B_qw1
    s_branch B_qr
B_redo:
    s_mov_b32 s33, -1
    s_nop 7
    v_mov_b32 v241, s15
    v_and_b32 v250, 8, v1
    v_lshlrev_b32 v250, 3, v250
    v_and_b32 v251, 48, v1
    v_add_u32 v250, v250, v251
    v_and_b32 v251, 7, v1
    v_lshl_add_u32 v251, v251, 10, v250
    s_mov_b32 s45, 1048576
B_rl:
    buffer_load_dwordx4 v[16:19], v3, s[28:31], s36 offen offset:0 sc1
    buffer_load_dwordx4 v[20:23], v3, s[28:31], s36 offen offset:1024 sc1
    buffer_load_dwordx4 v[24:27], v3, s[28:31], s36 offen offset:2048 sc1
    buffer_load_dwordx4 v[28:31], v3, s[28:31], s36 offen offset:3072 sc1
    buffer_load_dwordx4 v[32:35], v3, s[28:31], s37 offen offset:0 sc1
    buffer_load_dwordx4 v[36:39], v3, s[28:31], s37 offen offset:1024 sc1
    buffer_load_dwordx4 v[40:43], v3, s[28:31], s37 offen offset:2048 sc1
    buffer_load_dwordx4 v[44:47], v3, s[28:31], s37 offen offset:3072 sc1
    buffer_load_dwordx4 v[48:51], v3, s[28:31], s38 offen offset:0 sc1
    buffer_load_dwordx4 v[52:55], v3, s[28:31], s38 offen offset:1024 sc1
    buffer_load_dwordx4 v[56:59], v3, s[28:31], s38 offen offset:2048 sc1
    buffer_load_dwordx4 v[60:63], v3, s[28:31], s38 offen offset:3072 sc1
    buffer_load_dwordx4 v[64:67], v3, s[28:31], s39 offen offset:0 sc1
    buffer_load_dwordx4 v[68:71], v3, s[28:31], s39 offen offset:1024 sc1
    buffer_load_dwordx4 v[72:75], v3, s[28:31], s39 offen offset:2048 sc1
    buffer_load_dwordx4 v[76:79], v3, s[28:31], s39 offen offset:3072 sc1
    s_waitcnt vmcnt(0)
    v_max_u32 v10, v16, v17
    v_max3_u32 v10, v10, v18, v19
    v_max3_u32 v10, v10, v20, v21
    v_max3_u32 v10, v10, v22, v23
    v_max3_u32 v10, v10, v24, v25
    v_max3_u32 v10, v10, v26, v27
    v_max3_u32 v10, v10, v28, v29
    v_max3_u32 v10, v10, v30, v31
    v_max3_u32 v10, v10, v32, v33
    v_max3_u32 v10, v10, v34, v35
    v_max3_u32 v10, v10, v36, v37
    v_max3_u32 v10, v10, v38, v39
    v_max3_u32 v10, v10, v40, v41
    v_max3_u32 v10, v10, v42, v43
    v_max3_u32 v10, v10, v44, v45
    v_max3_u32 v10, v10, v46, v47
    v_max3_u32 v10, v10, v48, v49
    v_max3_u32 v10, v10, v50, v51
    v_max3_u32 v10, v10, v52, v53
    v_max3_u32 v10, v10, v54, v55
    v_max3_u32 v10, v10, v56, v57
    v_max3_u32 v10, v10, v58, v59
    v_max3_u32 v10, v10, v60, v61
    v_max3_u32 v10, v10, v62, v63
    v_max3_u32 v10, v10, v64, v65
    v_max3_u32 v10, v10, v66, v67
    v_max3_u32 v10, v10, v68, v69
    v_max3_u32 v10, v10, v70, v71
    v_max3_u32 v10, v10, v72, v73
    v_max3_u32 v10, v10, v74, v75
    v_max3_u32 v10, v10, v76, v77
    v_max3_u32 v10, v10, v78, v79
    v_cmp_eq_u32 vcc, -1, v10
    s_cbranch_vccz B_rld
    s_sub_u32 s45, s45, 1
    s_cbranch_scc0 B_rl
B_rld:
    s_add_u32 m0, s42, 0
    s_nop 0
    buffer_load_dwordx4 v3, s[28:31], s38 offen offset:0 sc1 lds
    buffer_load_dwordx4 v3, s[28:31], s38 offen offset:1024 sc1 lds
    buffer_load_dwordx4 v3, s[28:31], s38 offen offset:2048 sc1 lds
    s_waitcnt vmcnt(0)
    v_mov_b32 v216, 0x7f800000
    v_mov_b32 v217, 0x7f800000
    v_mov_b32 v218, 0x7f800000
    v_mov_b32 v219, 0x7f800000
    v_add_u32 v11, s49, v0
    ds_write_b128 v11, v[216:219] offset:34816
    s_waitcnt lgkmcnt(0)
    s_barrier
    s_mov_b32 s50, 0
    v_mov_b32 v10, v3
    v_mov_b32 v11, v0
B_mx:
    ds_read_b128 v[112:115], v10 offset:40960
    s_waitcnt lgkmcnt(0)
    v_mfma_f32_32x32x16_bf16 v[136:151], v[16:19], v[112:115], 0
    s_nop 11
    v_max_f32 v216, v136, v137
    v_max3_f32 v216, v216, v138, v139
    v_max3_f32 v216, v216, v140, v141
    v_max3_f32 v216, v216, v142, v143
    v_max3_f32 v216, v216, v144, v145
    v_max3_f32 v216, v216, v146, v147
    v_max3_f32 v216, v216, v148, v149
    v_max3_f32 v216, v216, v150, v151
    v_mfma_f32_32x32x16_bf16 v[136:151], v[20:23], v[112:115], 0
    s_nop 11
    v_max3_f32 v216, v216, v136, v137
    v_max3_f32 v216, v216, v138, v139
    v_max3_f32 v216, v216, v140, v141
    v_max3_f32 v216, v216, v142, v143
    v_max3_f32 v216, v216, v144, v145
    v_max3_f32 v216, v216, v146, v147
    v_max3_f32 v216, v216, v148, v149
    v_max3_f32 v216, v216, v150, v151
    v_mfma_f32_32x32x16_bf16 v[136:151], v[24:27], v[112:115], 0
    s_nop 11
    v_max3_f32 v216, v216, v136, v137
    v_max3_f32 v216, v216, v138, v139
    v_max3_f32 v216, v216, v140, v141
    v_max3_f32 v216, v216, v142, v143
    v_max3_f32 v216, v216, v144, v145
    v_max3_f32 v216, v216, v146, v147
    v_max3_f32 v216, v216, v148, v149
    v_max3_f32 v216, v216, v150, v151
    v_mfma_f32_32x32x16_bf16 v[136:151], v[28:31], v[112:115], 0
    s_nop 11
    v_max3_f32 v216, v216, v136, v137
    v_max3_f32 v216, v216, v138, v139
    v_max3_f32 v216, v216, v140, v141
    v_max3_f32 v216, v216, v142, v143
    v_max3_f32 v216, v216, v144, v145
    v_max3_f32 v216, v216, v146, v147
    v_max3_f32 v216, v216, v148, v149
    v_max3_f32 v216, v216, v150, v151
    v_mfma_f32_32x32x16_bf16 v[136:151], v[32:35], v[112:115], 0
    s_nop 11
    v_max3_f32 v216, v216, v136, v137
    v_max3_f32 v216, v216, v138, v139
    v_max3_f32 v216, v216, v140, v141
    v_max3_f32 v216, v216, v142, v143
    v_max3_f32 v216, v216, v144, v145
    v_max3_f32 v216, v216, v146, v147
    v_max3_f32 v216, v216, v148, v149
    v_max3_f32 v216, v216, v150, v151
    v_mfma_f32_32x32x16_bf16 v[136:151], v[36:39], v[112:115], 0
    s_nop 11
    v_max3_f32 v216, v216, v136, v137
    v_max3_f32 v216, v216, v138, v139
    v_max3_f32 v216, v216, v140, v141
    v_max3_f32 v216, v216, v142, v143
    v_max3_f32 v216, v216, v144, v145
    v_max3_f32 v216, v216, v146, v147
    v_max3_f32 v216, v216, v148, v149
    v_max3_f32 v216, v216, v150, v151
    v_mfma_f32_32x32x16_bf16 v[136:151], v[40:43], v[112:115], 0
    s_nop 11
    v_max3_f32 v216, v216, v136, v137
    v_max3_f32 v216, v216, v138, v139
    v_max3_f32 v216, v216, v140, v141
    v_max3_f32 v216, v216, v142, v143
    v_max3_f32 v216, v216, v144, v145
    v_max3_f32 v216, v216, v146, v147
    v_max3_f32 v216, v216, v148, v149
    v_max3_f32 v216, v216, v150, v151
    v_mfma_f32_32x32x16_bf16 v[136:151], v[44:47], v[112:115], 0
    s_nop 11
    v_max3_f32 v216, v216, v136, v137
    v_max3_f32 v216, v216, v138, v139
    v_max3_f32 v216, v216, v140, v141
    v_max3_f32 v216, v216, v142, v143
    v_max3_f32 v216, v216, v144, v145
    v_max3_f32 v216, v216, v146, v147
    v_max3_f32 v216, v216, v148, v149
    v_max3_f32 v216, v216, v150, v151
    v_sub_f32 v216, 0, v216
    ds_min_f32 v11, v216 offset:34816
    ds_min_f32 v11, v216 offset:34820
    ds_min_f32 v11, v216 offset:34824
    ds_min_f32 v11, v216 offset:34828
    v_add_u32 v10, 1024, v10
    v_add_u32 v11, 512, v11
    s_add_u32 s50, s50, 1
    s_cmp_lt_u32 s50, 8
    s_cbranch_scc1 B_mx
    s_nop 7
    v_mov_b32 v12, 0
    v_mov_b32 v13, 0x7f800000
    v_mfma_f32_32x32x16_bf16 v[168:183], v[116:119], v[116:119], 0
    v_mfma_f32_32x32x16_bf16 v[184:199], v[116:119], v[116:119], 0
    s_cmp_lg_u32 s32, 6
    s_cbranch_scc1 B_pi1
    ds_write_b32 v2, v116
    v_lshlrev_b32 v120, 4, v0
    v_mov_b32 v124, 0x45804580
    v_mov_b32 v125, 0x45804580
    v_mov_b32 v126, 0x45804580
    v_mov_b32 v127, 0x45804580
    s_mov_b64 exec, 0x33333333
    ds_write_b128 v120, v[124:127] offset:17408
    ds_write_b128 v120, v[116:119] offset:17424
    v_lshl_add_u32 v120, v120, 1, v2
    s_mov_b64 exec, 0x3
    ds_write_b128 v120, v[116:119] offset:2304
    ds_write_b128 v120, v[116:119] offset:3328
    s_mov_b64 exec, -1
B_pi1:
    v_add_u32 v10, s48, v3
    s_nop 7
    s_branch B_start
CODE_END:
.section .rodata,"a"
.p2align 6
.amdhsa_kernel sequential_preLN__grouped_kv_mqa__moe_arch_mod__prompt_kernel
  .amdhsa_next_free_vgpr 256
  .amdhsa_next_free_sgpr 102
  .amdhsa_accum_offset 256
  .amdhsa_group_segment_fixed_size 0
  .amdhsa_kernarg_size 104
  .amdhsa_user_sgpr_count 2
  .amdhsa_user_sgpr_kernarg_segment_ptr 1
  .amdhsa_system_sgpr_workgroup_id_x 1
.end_amdhsa_kernel
```
